```python
import torch

def _softmax(x, axis=-1):
    return torch.softmax(x, dim=axis)

def _gelu(x):
    return torch.nn.functional.gelu(x, approximate='tanh')

def _silu(x):
    return torch.nn.functional.silu(x)

def _sigmoid(x):
    return torch.sigmoid(x)

def _layernorm(x, axis=-1, eps=1e-05):
    m = x.mean(dim=axis, keepdim=True)
    v = x.var(dim=axis, keepdim=True, unbiased=False)
    return (x - m) / torch.sqrt(v + eps)

def _scatter_add(tgt, idx, src, axis=0):
    return tgt.clone().index_add_(axis, idx, src)

def _segment_sum(src, seg, n):
    out = torch.zeros((n,) + src.shape[1:], dtype=src.dtype)
    return out.index_add_(0, seg, src)

def _pad(x, pw):
    flat = tuple((v for pair in reversed(pw) for v in pair))
    return torch.nn.functional.pad(x, flat)
kernel_name = 'adaLN_cond__ssm_conv_h3__glu_gated_bilinear__prompt'

def setup_inputs():

    _w = lambda a: (lambda t: t.to(torch.bfloat16) if t.is_floating_point() else t)(torch.as_tensor(a))

    def _A_setup():
        B, S, D = (1, 2048, 640)
        ks = 4
        return {'q': _w((lambda *s: torch.randn(*s, dtype=torch.bfloat16) * 0.05)(B, S, D)), 'k': _w((lambda *s: torch.randn(*s, dtype=torch.bfloat16) * 1.6)(B, S, D)), 'v': _w((lambda *s: torch.randn(*s, dtype=torch.bfloat16) * 1.6)(B, S, D)), 'shift_k': _w((lambda *s: torch.randn(*s, dtype=torch.bfloat16) * 1.6)(D, ks) * 0.5), 'ssm_k': _w((lambda *s: torch.randn(*s, dtype=torch.bfloat16) * 1.6)(D, S) * (1.0 / S ** 0.5)), 'ssm_D': _w((lambda *s: torch.randn(*s, dtype=torch.bfloat16) * 1.6)(D))}
    _A_in = _A_setup()

    def _B_setup():
        B, S, D, F = (1, 2048, 640, 1728)
        return {'x': _w((lambda *s: torch.randn(*s, dtype=torch.bfloat16) * 0.05)(B, S, D)), 'w_gate': _w((lambda *s: torch.randn(*s, dtype=torch.bfloat16) * 3.2)(D, F) * D ** (-0.5)), 'w_up': _w((lambda *s: torch.randn(*s, dtype=torch.bfloat16) * 3.2)(D, F) * D ** (-0.5)), 'w_down': _w((lambda *s: torch.randn(*s, dtype=torch.bfloat16) * 3.2)(F, D) * F ** (-0.5))}
    _B_in = _B_setup()
    return {'A_q': _A_in['q'], 'A_k': _A_in['k'], 'A_v': _A_in['v'], 'A_shift_k': _A_in['shift_k'], 'A_ssm_k': _A_in['ssm_k'], 'A_ssm_D': _A_in['ssm_D'], 'B_x': _B_in['x'], 'B_w_gate': _B_in['w_gate'], 'B_w_up': _B_in['w_up'], 'B_w_down': _B_in['w_down'], 'c': _w((lambda *s: torch.randn(*s, dtype=torch.bfloat16) * 0.1)(1, 640) * 8.0), 'w_mod': _w((lambda *s: torch.randn(*s, dtype=torch.bfloat16) * 0.1)(640, 6 * 640) * 640 ** (-0.5) * 8.0)}

def reference(A_q, A_k, A_v, A_shift_k, A_ssm_k, A_ssm_D, B_x, B_w_gate, B_w_up, B_w_down, c, w_mod):

    def _A_ref(q, k, v, shift_k, ssm_k, ssm_D):
        B, S, D = q.shape
        ks = shift_k.shape[-1]
        k_pad = _pad(k, ((0, 0), (ks - 1, 0), (0, 0)))
        k_shift = torch.zeros_like(k)
        for t in range(ks):
            k_shift = k_shift + k_pad[:, t:t + S, :] * shift_k[:, ks - 1 - t][None, None, :]
        kv = k_shift * v
        L = 2 * S
        kv_pad = _pad(kv, ((0, 0), (0, S), (0, 0)))
        kf_pad = _pad(ssm_k, ((0, 0), (0, S)))
        kv_f = (lambda x, axes=(-2, -1): torch.fft.rfft2(x.float(), dim=axes))(kv_pad[:, None, :, :], axes=(1, 2))
        kf_f = (lambda x, axes=(-2, -1): torch.fft.rfft2(x.float(), dim=axes))(kf_pad[:, None, :], axes=(1, 2))
        kf_f = (lambda x, *d: x.permute(*d))(kf_f, 1, 2, 0)
        y_f = kv_f * kf_f[None, :, :, :]
        y = (lambda x, s, axes=(-2, -1): torch.fft.irfft2(x, s=s, dim=axes).to(torch.bfloat16))(y_f, (1, L), axes=(1, 2))[:, 0, :S, :]
        y = y + kv * ssm_D[None, None, :]
        return q * y

    def _B_ref(x, w_gate, w_up, w_down):
        g = torch.einsum('bsd,df->bsf', x, w_gate)
        u = torch.einsum('bsd,df->bsf', x, w_up)
        h = g * u
        return torch.einsum('bsf,fd->bsd', h, w_down)
    x = A_q
    mod = (_silu(c) @ w_mod).reshape(c.shape[0], 6, 1, -1)
    sa, ca, ga, sb, cb, gb = (mod[:, 0].clone(), mod[:, 1].clone(), mod[:, 2].clone(), mod[:, 3].clone(), mod[:, 4].clone(), mod[:, 5].clone())
    h = _layernorm(x, axis=-1) * (1 + ca) + sa
    x = x + ga * _A_ref(h, A_k, A_v, A_shift_k, A_ssm_k, A_ssm_D)
    h = _layernorm(x, axis=-1) * (1 + cb) + sb
    x = x + gb * _B_ref(h, B_w_gate, B_w_up, B_w_down)
    return x
```

```asm
; @launch grid=(256,1,1) block=(256,1,1) lds=163840
.amdgcn_target "amdgcn-amd-amdhsa--gfx950"
.text
.globl adaLN_cond__ssm_conv_h3__glu_gated_bilinear__prompt_kernel
.p2align 8
.type adaLN_cond__ssm_conv_h3__glu_gated_bilinear__prompt_kernel,@function
adaLN_cond__ssm_conv_h3__glu_gated_bilinear__prompt_kernel:
    s_cmp_ge_u32 s2, 256
    s_cbranch_scc1 L_end
    s_load_dwordx16 s[36:51], s[0:1], 0
    s_load_dwordx8 s[52:59], s[0:1], 64
    s_load_dwordx4 s[60:63], s[0:1], 96
    s_load_dwordx2 s[64:65], s[0:1], 112
    s_and_b32 s28, s2, 7
    s_lshr_b32 s29, s2, 3
    v_and_b32 v1, 63, v0
    v_lshrrev_b32 v2, 6, v0
    s_mov_b32 s35, 0xffff0000
    v_readfirstlane_b32 s30, v2
    s_cmp_lt_u32 s29, 30
    s_cbranch_scc1 L_p_1
    s_getpc_b64 s[24:25]
L_pc:
    s_sub_u32 s24, s24, L_pc-adaLN_cond__ssm_conv_h3__glu_gated_bilinear__prompt_kernel
    s_subb_u32 s25, s25, 0
    s_sub_u32 s33, s29, 30
    s_lshl_b32 s33, s33, 8
    v_add_u32 v14, s33, v0
    v_lshlrev_b32 v14, 7, v14
    s_mov_b32 s33, L_end-adaLN_cond__ssm_conv_h3__glu_gated_bilinear__prompt_kernel
    v_min_u32 v14, s33, v14
    v_mov_b32 v15, s25
    v_add_co_u32 v14, vcc, s24, v14
    s_nop 1
    v_addc_co_u32 v15, vcc, 0, v15, vcc
    global_load_dword v16, v[14:15], off
L_p_1:
    v_mul_u32_u24 v7, 205, v1
    v_lshrrev_b32 v7, 12, v7
    v_mul_u32_u24 v6, 20, v7
    v_sub_u32 v6, v1, v6
    v_cmp_gt_u32 vcc, 3, v7
    s_mul_i32 s33, s30, 3
    v_add_u32 v7, s33, v7
    v_cmp_gt_u32 s[26:27], 11, v7
    s_mul_i32 s33, s29, 11
    v_add_u32 v7, s33, v7
    v_lshrrev_b32 v8, 8, v7
    s_and_b64 s[26:27], s[26:27], vcc
    v_cmp_eq_u32 vcc, 0, v8
    v_lshlrev_b32 v7, 3, v7
    s_mul_i32 s34, s28, 80
    v_lshlrev_b32 v6, 2, v6
    v_add_u32 v6, s34, v6
    s_and_b64 s[26:27], s[26:27], vcc
    v_mul_u32_u24 v8, 1280, v7
    v_lshl_add_u32 v8, v6, 1, v8
    v_subrev_u32 v9, 3840, v8
    v_cmp_eq_u32 vcc, 0, v7
    v_bfrev_b32 v10, 2
    s_nop 0
    v_cndmask_b32 v9, v9, v10, vcc
    v_lshlrev_b32 v10, 3, v6
    v_lshlrev_b32 v11, 12, v6
    v_lshl_add_u32 v11, v7, 1, v11
    s_movk_i32 s66, 3840
    s_movk_i32 s67, 7680
    v_mov_b32 v3, 0x1782200
    s_waitcnt lgkmcnt(0)
    s_mov_b32 s4, s64
    s_and_b32 s5, s65, 0xffff
    s_mov_b32 s6, 0x1790000
    s_mov_b32 s7, 0x20000
    s_mov_b32 s8, s38
    s_and_b32 s9, s39, 0xffff
    s_mov_b32 s10, 0x280000
    s_mov_b32 s11, 0x20000
    s_mov_b32 s12, s40
    s_and_b32 s13, s41, 0xffff
    s_mov_b32 s14, 0x280000
    s_mov_b32 s15, 0x20000
    s_mov_b32 s16, s42
    s_and_b32 s17, s43, 0xffff
    s_mov_b32 s18, 0x1400
    s_mov_b32 s19, 0x20000
    s_cmp_ge_u32 s29, 24
    s_cbranch_scc1 L_p_4
    s_mov_b64 exec, s[26:27]
    s_cbranch_execz L_p_5
    buffer_load_dwordx2 v[22:23], v8, s[8:11], 0 offen offset:0
    buffer_load_dwordx2 v[24:25], v8, s[8:11], 0 offen offset:1280
    buffer_load_dwordx2 v[26:27], v8, s[8:11], 0 offen offset:2560
    buffer_load_dwordx2 v[28:29], v8, s[8:11], s66 offen offset:0
    buffer_load_dwordx2 v[30:31], v8, s[8:11], s66 offen offset:1280
    buffer_load_dwordx2 v[32:33], v8, s[8:11], s66 offen offset:2560
    buffer_load_dwordx2 v[34:35], v8, s[8:11], s67 offen offset:0
    buffer_load_dwordx2 v[36:37], v8, s[8:11], s67 offen offset:1280
    buffer_load_dwordx2 v[16:17], v9, s[8:11], 0 offen offset:0
    buffer_load_dwordx2 v[18:19], v9, s[8:11], 0 offen offset:1280
    buffer_load_dwordx2 v[20:21], v9, s[8:11], 0 offen offset:2560
    buffer_load_dwordx4 v[54:57], v10, s[16:19], 0 offen
    buffer_load_dwordx4 v[58:61], v10, s[16:19], 0 offen offset:16
    buffer_load_dwordx2 v[38:39], v8, s[12:15], 0 offen offset:0
    buffer_load_dwordx2 v[40:41], v8, s[12:15], 0 offen offset:1280
    buffer_load_dwordx2 v[42:43], v8, s[12:15], 0 offen offset:2560
    buffer_load_dwordx2 v[44:45], v8, s[12:15], s66 offen offset:0
    buffer_load_dwordx2 v[46:47], v8, s[12:15], s66 offen offset:1280
    buffer_load_dwordx2 v[48:49], v8, s[12:15], s66 offen offset:2560
    buffer_load_dwordx2 v[50:51], v8, s[12:15], s67 offen offset:0
    buffer_load_dwordx2 v[52:53], v8, s[12:15], s67 offen offset:1280
L_p_5:
    s_mov_b64 exec, -1
    s_cmp_lg_u32 s30, 3
    s_cbranch_scc1 L_p_6
    buffer_load_dword v4, v3, s[4:7], 0 offen sc1
L_p_6:
    s_cmp_ge_u32 s29, 20
    s_cbranch_scc1 L_p_7
    s_mov_b32 s20, s44
    s_and_b32 s21, s45, 0xffff
    s_mov_b32 s22, 0x280000
    s_mov_b32 s23, 0x20000
    s_mul_i32 s49, s28, 80
    s_lshl_b32 s33, s29, 2
    s_add_u32 s49, s49, s33
    s_add_u32 s38, s49, s30
    s_lshl_b32 s34, s38, 12
    v_lshl_add_u32 v166, v1, 4, s34
    v_and_b32 v167, 15, v1
    v_lshrrev_b32 v168, 4, v1
    v_add_u32 v169, v167, v168
    v_subrev_u32 v169, 16, v169
    v_cmp_gt_i32 vcc, 0, v169
    v_lshl_add_u32 v169, v169, 1, s34
    v_bfrev_b32 v170, 2
    v_cndmask_b32 v169, v169, v170, vcc
    s_mul_i32 s62, s30, 21248
    s_add_u32 s62, s62, 78848
    s_lshr_b32 s33, s38, 1
    s_lshl_b32 s33, s33, 2
    s_load_dword s48, s[46:47], s33
    buffer_load_ushort v164, v169, s[20:23], 0 offen
    s_mov_b64 exec, s[26:27]
    s_cbranch_execz L_p_8
    s_cmp_lg_u32 s30, 3
    s_cbranch_scc1 L_p_9
    s_waitcnt vmcnt(10)
    s_branch L_p_10
L_p_9:
    s_waitcnt vmcnt(9)
L_p_10:
    s_mov_b64 exec, -1
    buffer_load_dwordx4 v[140:143], v166, s[20:23], 0 offen offset:0
    buffer_load_dwordx2 v[144:145], v166, s[20:23], 16 offen offset:0
    buffer_load_dwordx4 v[146:149], v166, s[20:23], 0 offen offset:1024
    buffer_load_dwordx2 v[150:151], v166, s[20:23], 16 offen offset:1024
    buffer_load_dwordx4 v[152:155], v166, s[20:23], 0 offen offset:2048
    buffer_load_dwordx2 v[156:157], v166, s[20:23], 16 offen offset:2048
    buffer_load_dwordx4 v[158:161], v166, s[20:23], 0 offen offset:3072
    buffer_load_dwordx2 v[162:163], v166, s[20:23], 16 offen offset:3072
    s_add_u32 m0, s62, 32
    s_nop 0
    buffer_load_dwordx4 v166, s[20:23], 0 offen offset:0 lds
    buffer_load_dwordx4 v166, s[20:23], 0 offen offset:1024 lds
    buffer_load_dwordx4 v166, s[20:23], 0 offen offset:2048 lds
    buffer_load_dwordx4 v166, s[20:23], 0 offen offset:3072 lds
    s_add_u32 m0, s62, 8352
    s_nop 0
    buffer_load_dwordx4 v166, s[20:23], 4 offen offset:0 lds
    buffer_load_dwordx4 v166, s[20:23], 4 offen offset:1024 lds
    buffer_load_dwordx4 v166, s[20:23], 4 offen offset:2048 lds
    buffer_load_dwordx4 v166, s[20:23], 4 offen offset:3072 lds
    s_mov_b64 exec, s[26:27]
    v_lshlrev_b32 v62, 16, v54
    v_and_b32 v66, s35, v54
    v_lshlrev_b32 v70, 16, v55
    v_and_b32 v74, s35, v55
    v_lshlrev_b32 v63, 16, v56
    v_and_b32 v67, s35, v56
    v_lshlrev_b32 v71, 16, v57
    v_and_b32 v75, s35, v57
    v_lshlrev_b32 v64, 16, v58
    v_and_b32 v68, s35, v58
    v_lshlrev_b32 v72, 16, v59
    v_and_b32 v76, s35, v59
    v_lshlrev_b32 v65, 16, v60
    v_and_b32 v69, s35, v60
    v_lshlrev_b32 v73, 16, v61
    v_and_b32 v77, s35, v61
    v_lshlrev_b32 v78, 16, v16
    v_and_b32 v79, s35, v16
    v_lshlrev_b32 v80, 16, v17
    v_and_b32 v81, s35, v17
    v_lshlrev_b32 v82, 16, v18
    v_and_b32 v83, s35, v18
    v_lshlrev_b32 v84, 16, v19
    v_and_b32 v85, s35, v19
    v_lshlrev_b32 v86, 16, v20
    v_and_b32 v87, s35, v20
    v_lshlrev_b32 v88, 16, v21
    v_and_b32 v89, s35, v21
    v_lshlrev_b32 v90, 16, v22
    v_and_b32 v91, s35, v22
    v_lshlrev_b32 v92, 16, v23
    v_and_b32 v93, s35, v23
    v_lshlrev_b32 v94, 16, v24
    v_and_b32 v95, s35, v24
    v_lshlrev_b32 v96, 16, v25
    v_and_b32 v97, s35, v25
    v_lshlrev_b32 v98, 16, v26
    v_and_b32 v99, s35, v26
    v_lshlrev_b32 v100, 16, v27
    v_and_b32 v101, s35, v27
    v_lshlrev_b32 v102, 16, v28
    v_and_b32 v103, s35, v28
    v_lshlrev_b32 v104, 16, v29
    v_and_b32 v105, s35, v29
    v_lshlrev_b32 v106, 16, v30
    v_and_b32 v107, s35, v30
    v_lshlrev_b32 v108, 16, v31
    v_and_b32 v109, s35, v31
    v_lshlrev_b32 v110, 16, v32
    v_and_b32 v111, s35, v32
    v_lshlrev_b32 v112, 16, v33
    v_and_b32 v113, s35, v33
    v_lshlrev_b32 v114, 16, v34
    v_and_b32 v115, s35, v34
    v_lshlrev_b32 v116, 16, v35
    v_and_b32 v117, s35, v35
    v_lshlrev_b32 v118, 16, v36
    v_and_b32 v119, s35, v36
    v_lshlrev_b32 v120, 16, v37
    v_and_b32 v121, s35, v37
    v_pk_mul_f32 v[122:123], v[78:79], v[74:75]
    v_pk_mul_f32 v[124:125], v[80:81], v[76:77]
    v_pk_mul_f32 v[126:127], v[82:83], v[74:75]
    v_pk_mul_f32 v[128:129], v[84:85], v[76:77]
    v_pk_fma_f32 v[122:123], v[82:83], v[70:71], v[122:123]
    v_pk_fma_f32 v[124:125], v[84:85], v[72:73], v[124:125]
    v_pk_fma_f32 v[126:127], v[86:87], v[70:71], v[126:127]
    v_pk_fma_f32 v[128:129], v[88:89], v[72:73], v[128:129]
    v_pk_fma_f32 v[122:123], v[86:87], v[66:67], v[122:123]
    v_pk_fma_f32 v[124:125], v[88:89], v[68:69], v[124:125]
    v_pk_fma_f32 v[126:127], v[90:91], v[66:67], v[126:127]
    v_pk_fma_f32 v[128:129], v[92:93], v[68:69], v[128:129]
    v_pk_fma_f32 v[78:79], v[90:91], v[62:63], v[122:123]
    v_pk_fma_f32 v[80:81], v[92:93], v[64:65], v[124:125]
    v_pk_fma_f32 v[82:83], v[94:95], v[62:63], v[126:127]
    v_pk_fma_f32 v[84:85], v[96:97], v[64:65], v[128:129]
    v_pk_mul_f32 v[122:123], v[86:87], v[74:75]
    v_pk_mul_f32 v[124:125], v[88:89], v[76:77]
    v_pk_mul_f32 v[126:127], v[90:91], v[74:75]
    v_pk_mul_f32 v[128:129], v[92:93], v[76:77]
    v_pk_fma_f32 v[122:123], v[90:91], v[70:71], v[122:123]
    v_pk_fma_f32 v[124:125], v[92:93], v[72:73], v[124:125]
    v_pk_fma_f32 v[126:127], v[94:95], v[70:71], v[126:127]
    v_pk_fma_f32 v[128:129], v[96:97], v[72:73], v[128:129]
    v_pk_fma_f32 v[122:123], v[94:95], v[66:67], v[122:123]
    v_pk_fma_f32 v[124:125], v[96:97], v[68:69], v[124:125]
    v_pk_fma_f32 v[126:127], v[98:99], v[66:67], v[126:127]
    v_pk_fma_f32 v[128:129], v[100:101], v[68:69], v[128:129]
    v_pk_fma_f32 v[86:87], v[98:99], v[62:63], v[122:123]
    v_pk_fma_f32 v[88:89], v[100:101], v[64:65], v[124:125]
    v_pk_fma_f32 v[90:91], v[102:103], v[62:63], v[126:127]
    v_pk_fma_f32 v[92:93], v[104:105], v[64:65], v[128:129]
    v_pk_mul_f32 v[122:123], v[94:95], v[74:75]
    v_pk_mul_f32 v[124:125], v[96:97], v[76:77]
    v_pk_mul_f32 v[126:127], v[98:99], v[74:75]
    v_pk_mul_f32 v[128:129], v[100:101], v[76:77]
    v_pk_fma_f32 v[122:123], v[98:99], v[70:71], v[122:123]
    v_pk_fma_f32 v[124:125], v[100:101], v[72:73], v[124:125]
    v_pk_fma_f32 v[126:127], v[102:103], v[70:71], v[126:127]
    v_pk_fma_f32 v[128:129], v[104:105], v[72:73], v[128:129]
    v_pk_fma_f32 v[122:123], v[102:103], v[66:67], v[122:123]
    v_pk_fma_f32 v[124:125], v[104:105], v[68:69], v[124:125]
    v_pk_fma_f32 v[126:127], v[106:107], v[66:67], v[126:127]
    v_pk_fma_f32 v[128:129], v[108:109], v[68:69], v[128:129]
    v_pk_fma_f32 v[94:95], v[106:107], v[62:63], v[122:123]
    v_pk_fma_f32 v[96:97], v[108:109], v[64:65], v[124:125]
    v_pk_fma_f32 v[98:99], v[110:111], v[62:63], v[126:127]
    v_pk_fma_f32 v[100:101], v[112:113], v[64:65], v[128:129]
    v_pk_mul_f32 v[122:123], v[102:103], v[74:75]
    v_pk_mul_f32 v[124:125], v[104:105], v[76:77]
    v_pk_mul_f32 v[126:127], v[106:107], v[74:75]
    v_pk_mul_f32 v[128:129], v[108:109], v[76:77]
    v_pk_fma_f32 v[122:123], v[106:107], v[70:71], v[122:123]
    v_pk_fma_f32 v[124:125], v[108:109], v[72:73], v[124:125]
    v_pk_fma_f32 v[126:127], v[110:111], v[70:71], v[126:127]
    v_pk_fma_f32 v[128:129], v[112:113], v[72:73], v[128:129]
    v_pk_fma_f32 v[122:123], v[110:111], v[66:67], v[122:123]
    v_pk_fma_f32 v[124:125], v[112:113], v[68:69], v[124:125]
    v_pk_fma_f32 v[126:127], v[114:115], v[66:67], v[126:127]
    v_pk_fma_f32 v[128:129], v[116:117], v[68:69], v[128:129]
    v_pk_fma_f32 v[102:103], v[114:115], v[62:63], v[122:123]
    v_pk_fma_f32 v[104:105], v[116:117], v[64:65], v[124:125]
    v_pk_fma_f32 v[106:107], v[118:119], v[62:63], v[126:127]
    v_pk_fma_f32 v[108:109], v[120:121], v[64:65], v[128:129]
    s_cmp_lg_u32 s30, 3
    s_cbranch_scc1 L_p_11
    s_waitcnt vmcnt(18)
    s_branch L_p_12
L_p_11:
    s_waitcnt vmcnt(17)
L_p_12:
    v_lshlrev_b32 v122, 16, v38
    v_and_b32 v123, s35, v38
    v_lshlrev_b32 v124, 16, v39
    v_and_b32 v125, s35, v39
    v_pk_mul_f32 v[78:79], v[78:79], v[122:123]
    v_pk_mul_f32 v[80:81], v[80:81], v[124:125]
    v_lshlrev_b32 v126, 16, v40
    v_and_b32 v127, s35, v40
    v_lshlrev_b32 v128, 16, v41
    v_and_b32 v129, s35, v41
    v_pk_mul_f32 v[82:83], v[82:83], v[126:127]
    v_pk_mul_f32 v[84:85], v[84:85], v[128:129]
    v_lshlrev_b32 v130, 16, v42
    v_and_b32 v131, s35, v42
    v_lshlrev_b32 v132, 16, v43
    v_and_b32 v133, s35, v43
    v_pk_mul_f32 v[86:87], v[86:87], v[130:131]
    v_pk_mul_f32 v[88:89], v[88:89], v[132:133]
    v_lshlrev_b32 v134, 16, v44
    v_and_b32 v135, s35, v44
    v_lshlrev_b32 v136, 16, v45
    v_and_b32 v137, s35, v45
    v_pk_mul_f32 v[90:91], v[90:91], v[134:135]
    v_pk_mul_f32 v[92:93], v[92:93], v[136:137]
    v_lshlrev_b32 v122, 16, v46
    v_and_b32 v123, s35, v46
    v_lshlrev_b32 v124, 16, v47
    v_and_b32 v125, s35, v47
    v_pk_mul_f32 v[94:95], v[94:95], v[122:123]
    v_pk_mul_f32 v[96:97], v[96:97], v[124:125]
    v_lshlrev_b32 v126, 16, v48
    v_and_b32 v127, s35, v48
    v_lshlrev_b32 v128, 16, v49
    v_and_b32 v129, s35, v49
    v_pk_mul_f32 v[98:99], v[98:99], v[126:127]
    v_pk_mul_f32 v[100:101], v[100:101], v[128:129]
    v_lshlrev_b32 v130, 16, v50
    v_and_b32 v131, s35, v50
    v_lshlrev_b32 v132, 16, v51
    v_and_b32 v133, s35, v51
    v_pk_mul_f32 v[102:103], v[102:103], v[130:131]
    v_pk_mul_f32 v[104:105], v[104:105], v[132:133]
    v_lshlrev_b32 v134, 16, v52
    v_and_b32 v135, s35, v52
    v_lshlrev_b32 v136, 16, v53
    v_and_b32 v137, s35, v53
    v_pk_mul_f32 v[106:107], v[106:107], v[134:135]
    v_pk_mul_f32 v[108:109], v[108:109], v[136:137]
    s_movk_i32 s66, 4096
    s_movk_i32 s67, 8192
    s_movk_i32 s68, 12288
    v_cvt_pk_bf16_f32 v16, v106, v102
    v_cvt_pk_bf16_f32 v17, v98, v94
    v_cvt_pk_bf16_f32 v18, v90, v86
    v_cvt_pk_bf16_f32 v19, v82, v78
    buffer_store_dwordx4 v[16:19], v11, s[4:7], 0 offen
    v_cvt_pk_bf16_f32 v20, v107, v103
    v_cvt_pk_bf16_f32 v21, v99, v95
    v_cvt_pk_bf16_f32 v22, v91, v87
    v_cvt_pk_bf16_f32 v23, v83, v79
    buffer_store_dwordx4 v[20:23], v11, s[4:7], s66 offen
    v_cvt_pk_bf16_f32 v24, v108, v104
    v_cvt_pk_bf16_f32 v25, v100, v96
    v_cvt_pk_bf16_f32 v26, v92, v88
    v_cvt_pk_bf16_f32 v27, v84, v80
    buffer_store_dwordx4 v[24:27], v11, s[4:7], s67 offen
    v_cvt_pk_bf16_f32 v28, v109, v105
    v_cvt_pk_bf16_f32 v29, v101, v97
    v_cvt_pk_bf16_f32 v30, v93, v89
    v_cvt_pk_bf16_f32 v31, v85, v81
    buffer_store_dwordx4 v[28:31], v11, s[4:7], s68 offen
L_p_8:
    s_mov_b64 exec, -1
    s_cmp_lg_u32 s30, 3
    s_cbranch_scc1 L_p_13
    s_waitcnt vmcnt(4)
    s_getreg_b32 s44, hwreg(HW_REG_XCC_ID, 0, 4)
    s_mov_b32 s32, 0
    v_readfirstlane_b32 s31, v4
    s_nop 0
    s_mul_i32 s31, s31, 0x9e3779b1
    s_add_u32 s31, s31, 0x7f4a7c15
    s_add_u32 s44, s44, s31
L_p_13:
    s_bitcmp1_b32 s30, 0
    s_cselect_b32 s0, s52, s50
    s_cselect_b32 s1, s53, s51
    s_mov_b32 s24, s0
    s_and_b32 s25, s1, 0xffff
    s_mov_b32 s26, 0x21c000
    s_mov_b32 s27, 0x20000
    v_lshrrev_b32 v14, 3, v1
    s_lshr_b32 s33, s30, 1
    s_lshl_b32 s34, s33, 4
    v_add_u32 v14, s34, v14
    v_mul_u32_u24 v14, 3456, v14
    v_bfe_u32 v15, v1, 1, 2
    v_lshrrev_b32 v13, 4, v1
    v_xor_b32 v15, v15, v13
    v_lshlrev_b32 v15, 5, v15
    v_and_b32 v13, 1, v1
    v_lshl_add_u32 v15, v13, 4, v15
    v_add_u32 v14, v14, v15
    s_sub_u32 s45, s29, 4
    s_add_u32 s34, s29, 7
    s_cmp_lt_u32 s29, 24
    s_cselect_b32 s45, s34, s45
    s_cmp_lt_u32 s29, 20
    s_cselect_b32 s45, s29, s45
    s_cmp_eq_u32 s29, 31
    s_cselect_b32 s45, s29, s45
    s_lshl_b32 s34, s45, 7
    v_add_u32 v12, s34, v14
    v_add_u32 v13, 26624, v12
    s_and_b32 s34, s30, 1
    s_lshl_b32 s34, s34, 12
    s_lshl_b32 s33, s33, 11
    s_add_u32 s63, s33, s34
    s_waitcnt vmcnt(0)
    s_waitcnt lgkmcnt(0)
    s_barrier
    s_cmp_lg_u32 s30, 3
    s_cbranch_scc1 L_p_14
    s_lshl_b32 s33, s28, 10
    s_add_u32 s33, s33, 0x1780080
    s_lshl_b32 s34, s29, 2
    s_add_u32 s33, s33, s34
    v_mov_b32 v2, s33
    v_mov_b32 v3, s44
    s_mov_b32 exec_lo, 0x1
    s_mov_b32 exec_hi, 0
    s_cmp_lg_u32 s32, 0
    s_cbranch_scc1 L_p_15
    buffer_store_dword v3, v2, s[4:7], 0 offen
    s_branch L_p_16
L_p_15:
    buffer_wbl2 sc1
    s_waitcnt vmcnt(0)
    buffer_store_dword v3, v2, s[4:7], 0 offen sc1
L_p_16:
    s_mov_b64 exec, -1
L_p_14:
    s_lshl_b32 s33, s28, 5
    s_add_u32 s33, s33, s29
    s_mul_i32 s34, s30, 160
    v_and_b32 v2, 7, v1
    v_lshrrev_b32 v3, 3, v1
    v_lshl_add_u32 v4, v3, 2, s34
    s_lshl_b32 s66, s33, 3
    v_add_u32 v6, s66, v3
    v_mul_u32_u24 v6, 1280, v6
    v_lshl_add_u32 v6, v2, 3, v6
    s_lshl_b32 s66, s34, 1
    v_add_u32 v6, s66, v6
    v_lshlrev_b32 v15, 2, v4
    v_add_u32 v15, 65536, v15
    v_add_u32 v7, s34, v1
    v_lshlrev_b32 v7, 5, v7
    s_lshr_b32 s66, s33, 1
    s_and_b32 s67, s33, 1
    s_mul_i32 s68, s66, 20480
    s_lshl_b32 s33, s67, 4
    s_add_u32 s68, s68, s33
    s_add_u32 s68, s68, 0x300000
    v_add_u32 v7, s68, v7
    v_lshrrev_b32 v8, 4, v1
    v_lshlrev_b32 v8, 3, v8
    v_bfe_u32 v9, v1, 1, 1
    v_lshl_add_u32 v8, v9, 2, v8
    v_bfe_u32 v9, v1, 2, 2
    v_add_u32 v8, v8, v9
    v_lshlrev_b32 v8, 4, v8
    v_and_b32 v9, 1, v1
    v_lshl_add_u32 v8, v9, 3, v8
    s_mul_i32 s41, s30, 3072
    s_add_u32 s41, s41, 65536
    v_add_u32 v8, s41, v8
    v_lshlrev_b32 v10, 5, v2
    v_add_u32 v10, 78848, v10
    v_bfe_u32 v9, v1, 4, 1
    v_lshl_add_u32 v9, v9, 4, v10
    s_lshl_b32 s68, s30, 2
    v_add_u32 v9, s68, v9
    v_and_b32 v11, 3, v3
    v_lshlrev_b32 v11, 4, v11
    s_lshl_b32 s68, s67, 3
    v_add_u32 v11, s68, v11
    v_add_u32 v11, v11, v2
    v_lshlrev_b32 v11, 4, v11
    v_lshrrev_b32 v4, 2, v3
    v_lshl_add_u32 v11, v4, 3, v11
    s_mul_i32 s68, s66, 21
    s_mul_i32 s34, s30, 5
    s_add_u32 s68, s68, s34
    s_lshl_b32 s68, s68, 10
    s_add_u32 s68, s68, 0x600000
    v_add_u32 v11, s68, v11
    v_lshl_add_u32 v170, v1, 4, s62
    v_alignbit_b32 v16, v141, v140, 16
    v_alignbit_b32 v17, v142, v141, 16
    v_alignbit_b32 v18, v143, v142, 16
    v_alignbit_b32 v19, v144, v143, 16
    ds_write_b128 v170, v[16:19] offset:4192
    v_alignbit_b32 v20, v142, v141, 16
    v_alignbit_b32 v21, v143, v142, 16
    v_alignbit_b32 v22, v144, v143, 16
    v_alignbit_b32 v23, v145, v144, 16
    ds_write_b128 v170, v[20:23] offset:12512
    v_alignbit_b32 v24, v147, v146, 16
    v_alignbit_b32 v25, v148, v147, 16
    v_alignbit_b32 v26, v149, v148, 16
    v_alignbit_b32 v27, v150, v149, 16
    ds_write_b128 v170, v[24:27] offset:5216
    v_alignbit_b32 v28, v148, v147, 16
    v_alignbit_b32 v29, v149, v148, 16
    v_alignbit_b32 v30, v150, v149, 16
    v_alignbit_b32 v31, v151, v150, 16
    ds_write_b128 v170, v[28:31] offset:13536
    v_alignbit_b32 v16, v153, v152, 16
    v_alignbit_b32 v17, v154, v153, 16
    v_alignbit_b32 v18, v155, v154, 16
    v_alignbit_b32 v19, v156, v155, 16
    ds_write_b128 v170, v[16:19] offset:6240
    v_alignbit_b32 v20, v154, v153, 16
    v_alignbit_b32 v21, v155, v154, 16
    v_alignbit_b32 v22, v156, v155, 16
    v_alignbit_b32 v23, v157, v156, 16
    ds_write_b128 v170, v[20:23] offset:14560
    v_alignbit_b32 v24, v159, v158, 16
    v_alignbit_b32 v25, v160, v159, 16
    v_alignbit_b32 v26, v161, v160, 16
    v_alignbit_b32 v27, v162, v161, 16
    ds_write_b128 v170, v[24:27] offset:7264
    v_alignbit_b32 v28, v160, v159, 16
    v_alignbit_b32 v29, v161, v160, 16
    v_alignbit_b32 v30, v162, v161, 16
    v_alignbit_b32 v31, v163, v162, 16
    ds_write_b128 v170, v[28:31] offset:15584
    v_mul_u32_u24 v171, 4160, v168
    v_lshl_add_u32 v171, v167, 1, v171
    v_add_u32 v171, s62, v171
    ds_write_b16 v171, v164
    v_mov_b32 v32, 0
    v_mov_b32 v33, 0
    v_lshl_add_u32 v171, v1, 3, s62
    ds_write_b64 v171, v[32:33] offset:16640
    v_add_u32 v34, 1, v167
    v_and_b32 v35, 3, v34
    v_lshrrev_b32 v34, 2, v34
    v_mul_u32_u24 v35, 4160, v35
    v_lshlrev_b32 v36, 1, v168
    v_sub_u32 v34, v34, v36
    v_lshl_add_u32 v35, v34, 3, v35
    s_add_u32 s33, s62, 48
    v_add_u32 v172, s33, v35
    v_lshl_add_u32 v36, v167, 1, v168
    s_add_u32 s33, s62, 17120
    v_lshl_add_u32 v173, v36, 4, s33
    v_lshrrev_b32 v34, 1, v168
    v_lshl_add_u32 v34, v167, 1, v34
    v_lshlrev_b32 v34, 4, v34
    v_and_b32 v35, 1, v168
    v_xor_b32 v35, 1, v35
    v_lshl_add_u32 v34, v35, 3, v34
    s_add_u32 s33, s62, 17152
    v_add_u32 v174, s33, v34
    s_waitcnt lgkmcnt(0)
    ds_read_b64 v[48:49], v172 offset:0
    ds_read_b64 v[50:51], v172 offset:8
    ds_read_b64 v[52:53], v172 offset:512
    ds_read_b64 v[54:55], v172 offset:520
    ds_read_b64 v[56:57], v172 offset:1024
    ds_read_b64 v[58:59], v172 offset:1032
    ds_read_b64 v[60:61], v172 offset:1536
    ds_read_b64 v[62:63], v172 offset:1544
    ds_read_b64 v[64:65], v172 offset:2048
    ds_read_b64 v[66:67], v172 offset:2056
    ds_read_b64 v[68:69], v172 offset:2560
    ds_read_b64 v[70:71], v172 offset:2568
    ds_read_b64 v[72:73], v172 offset:3072
    ds_read_b64 v[74:75], v172 offset:3080
    ds_read_b64 v[76:77], v172 offset:3584
    ds_read_b64 v[78:79], v172 offset:3592
    v_mov_b32 v16, 0
    v_mov_b32 v17, 0
    v_mov_b32 v18, 0
    v_mov_b32 v19, 0
    v_mov_b32 v20, 0
    v_mov_b32 v21, 0
    v_mov_b32 v22, 0
    v_mov_b32 v23, 0
    v_mov_b32 v24, 0
    v_mov_b32 v25, 0
    v_mov_b32 v26, 0
    v_mov_b32 v27, 0
    v_mov_b32 v28, 0
    v_mov_b32 v29, 0
    v_mov_b32 v30, 0
    v_mov_b32 v31, 0
    v_mov_b32 v32, 0
    v_mov_b32 v33, 0
    v_mov_b32 v34, 0
    v_mov_b32 v35, 0
    v_mov_b32 v36, 0
    v_mov_b32 v37, 0
    v_mov_b32 v38, 0
    v_mov_b32 v39, 0
    v_mov_b32 v40, 0
    v_mov_b32 v41, 0
    v_mov_b32 v42, 0
    v_mov_b32 v43, 0
    v_mov_b32 v44, 0
    v_mov_b32 v45, 0
    v_mov_b32 v46, 0
    v_mov_b32 v47, 0
    s_and_b32 s33, s38, 1
    s_lshl_b32 s33, s33, 4
    s_lshr_b32 s48, s48, s33
    s_lshl_b32 s48, s48, 16
    v_mov_b32 v128, s48
    v_mov_b32 v129, s48
    v_bfe_u32 v130, v167, 2, 1
    v_lshlrev_b32 v130, 1, v130
    v_xor_b32 v130, v130, v168
    v_lshlrev_b32 v130, 3, v130
    v_lshl_add_u32 v130, v167, 5, v130
    v_add_u32 v130, s62, v130
    v_lshrrev_b32 v132, 3, v0
    v_and_b32 v133, 7, v0
    v_lshrrev_b32 v134, 1, v133
    v_mul_u32_u24 v134, 21248, v134
    v_lshl_add_u32 v134, v132, 5, v134
    v_lshrrev_b32 v135, 2, v132
    v_xor_b32 v135, v135, v133
    v_and_b32 v135, 1, v135
    v_lshl_add_u32 v134, v135, 4, v134
    v_add_u32 v134, 78848, v134
    v_mul_u32_u24 v135, 20480, v132
    v_lshl_add_u32 v135, v133, 4, v135
    s_lshl_b32 s33, s49, 5
    v_add_u32 v135, s33, v135
    s_waitcnt lgkmcnt(0)
    s_cmp_lg_u32 s30, 3
    s_cbranch_scc1 L_p_17
    s_lshl_b32 s33, s28, 10
    s_add_u32 s33, s33, 0x1780080
    v_lshl_add_u32 v2, v1, 2, s33
    s_mov_b32 exec_lo, 0xffffffff
    s_mov_b32 exec_hi, 0
    s_mov_b32 s3, 40
L_p_18:
    buffer_load_dword v3, v2, s[4:7], 0 offen sc1
    s_sub_u32 s3, s3, 1
    s_waitcnt vmcnt(0)
    v_cmp_ne_u32 vcc, s44, v3
    s_cbranch_vccz L_p_21
    s_cmp_lg_u32 s3, 0
    s_cbranch_scc1 L_p_18
    s_lshl_b32 s33, s28, 10
    s_add_u32 s33, s33, 0x1780000
    s_lshl_b32 s34, s29, 2
    s_add_u32 s33, s33, s34
    v_mov_b32 v2, s33
    v_mov_b32 v3, s44
    s_mov_b32 exec_lo, 0x1
    s_mov_b32 exec_hi, 0
    buffer_store_dword v3, v2, s[4:7], 0 offen sc1
    s_mov_b64 exec, -1
    s_lshl_b32 s33, s28, 10
    s_add_u32 s33, s33, 0x1780080
    v_lshl_add_u32 v2, v1, 2, s33
    v_lshrrev_b32 v4, 5, v1
    v_mul_u32_u24 v4, 256, v4
    v_sub_u32 v2, v2, v4
    s_mov_b32 s3, 1048576
L_p_19:
    buffer_load_dword v3, v2, s[4:7], 0 offen sc1
    s_sub_u32 s3, s3, 1
    s_cmp_eq_u32 s3, 0
    s_cbranch_scc1 L_end
    s_waitcnt vmcnt(0)
    v_cmp_ne_u32 vcc, s44, v3
    v_subrev_u32 v4, s31, v3
    v_cmp_le_u32 s[0:1], 8, v4
    s_cmp_eq_u32 vcc_lo, 0
    s_cbranch_scc1 L_p_21
    s_cmp_lg_u32 s1, 0
    s_cbranch_scc1 L_p_19
    s_cmp_eq_u32 vcc_hi, 0
    s_cbranch_scc1 L_p_19
    s_mov_b32 s32, 1
    s_add_u32 s44, s31, 8
    s_lshl_b32 s33, s28, 10
    s_add_u32 s33, s33, 0x1780080
    s_lshl_b32 s34, s29, 2
    s_add_u32 s33, s33, s34
    v_mov_b32 v2, s33
    v_mov_b32 v3, s44
    s_mov_b32 exec_lo, 0x1
    s_mov_b32 exec_hi, 0
    s_cmp_lg_u32 s32, 0
    s_cbranch_scc1 L_p_22
    buffer_store_dword v3, v2, s[4:7], 0 offen
    s_branch L_p_23
L_p_22:
    buffer_wbl2 sc1
    s_waitcnt vmcnt(0)
    buffer_store_dword v3, v2, s[4:7], 0 offen sc1
L_p_23:
    s_mov_b64 exec, -1
L_p_21:
    s_mov_b64 exec, -1
    s_cmp_eq_u32 s32, 0
    s_cbranch_scc1 L_p_24
    s_lshl_b32 s33, s28, 10
    s_add_u32 s33, s33, 0x1780080
    v_lshl_add_u32 v2, v1, 2, s33
    s_mov_b32 exec_lo, 0xffffffff
    s_mov_b32 exec_hi, 0
    s_mov_b32 s3, 1048576
L_p_25:
    buffer_load_dword v3, v2, s[4:7], 0 offen sc1
    s_waitcnt vmcnt(0)
    v_cmp_ne_u32 vcc, s44, v3
    s_cbranch_vccz L_p_26
    s_sub_u32 s3, s3, 1
    s_cmp_lg_u32 s3, 0
    s_cbranch_scc1 L_p_25
    s_mov_b64 exec, -1
    s_branch L_end
L_p_26:
    s_mov_b64 exec, -1
L_p_24:
L_p_17:
    s_barrier
    s_add_u32 m0, s62, 17152
    s_nop 0
    buffer_load_dwordx4 v166, s[4:7], 0 offen offset:0 sc1 lds
    buffer_load_dwordx4 v166, s[4:7], 0 offen offset:1024 sc1 lds
    buffer_load_dwordx4 v166, s[4:7], 0 offen offset:2048 sc1 lds
    buffer_load_dwordx4 v166, s[4:7], 0 offen offset:3072 sc1 lds
    s_mov_b32 s8, s36
    s_and_b32 s9, s37, 0xffff
    s_mov_b32 s10, 0x280000
    s_mov_b32 s11, 0x20000
    buffer_load_dwordx2 v[240:241], v6, s[8:11], 0 offen offset:0
    buffer_load_dwordx2 v[242:243], v6, s[8:11], 0 offen offset:64
    buffer_load_dwordx2 v[244:245], v6, s[8:11], 0 offen offset:128
    buffer_load_dwordx2 v[246:247], v6, s[8:11], 0 offen offset:192
    buffer_load_dwordx2 v[248:249], v6, s[8:11], 0 offen offset:256
    s_waitcnt vmcnt(5)
    ds_read_b128 v[108:111], v173 offset:3584
    ds_read_b128 v[104:107], v173 offset:3072
    ds_read_b128 v[100:103], v173 offset:2560
    ds_read_b128 v[96:99], v173 offset:2048
    ds_read_b128 v[80:83], v173 offset:0
    ds_read_b128 v[84:87], v173 offset:512
    ds_read_b128 v[88:91], v173 offset:1024
    ds_read_b128 v[92:95], v173 offset:1536
    ds_read_b64 v[112:113], v174 offset:0
    ds_read_b64 v[114:115], v174 offset:512
    ds_read_b64 v[116:117], v174 offset:1024
    ds_read_b64 v[118:119], v174 offset:1536
    ds_read_b64 v[120:121], v174 offset:2048
    ds_read_b64 v[122:123], v174 offset:2560
    ds_read_b64 v[124:125], v174 offset:3072
    ds_read_b64 v[126:127], v174 offset:3584
    v_add_u32 v172, 64, v172
    v_subrev_u32 v173, 64, v173
    s_mul_i32 s40, s28, 110592
    s_lshl_b32 s39, s28, 13
    s_mul_i32 s39, s39, 1
    s_add_u32 s39, s39, s63
    s_mov_b32 s69, 0
L_p_27:
    s_waitcnt lgkmcnt(15)
    v_mfma_f32_16x16x32_bf16 v[44:47], v[48:51], v[108:111], v[44:47]
    ds_read_b128 v[108:111], v173 offset:3584
    v_mfma_f32_16x16x32_bf16 v[40:43], v[48:51], v[104:107], v[40:43]
    s_mov_b32 m0, s39
    v_mfma_f32_16x16x32_bf16 v[36:39], v[48:51], v[100:103], v[36:39]
    buffer_load_dwordx4 v12, s[24:27], s40 offen lds
    v_mfma_f32_16x16x32_bf16 v[32:35], v[48:51], v[96:99], v[32:35]
    v_mfma_f32_16x16x32_bf16 v[44:47], v[52:55], v[104:107], v[44:47]
    ds_read_b128 v[104:107], v173 offset:3072
    v_mfma_f32_16x16x32_bf16 v[40:43], v[52:55], v[100:103], v[40:43]
    v_mfma_f32_16x16x32_bf16 v[36:39], v[52:55], v[96:99], v[36:39]
    s_waitcnt lgkmcnt(15)
    v_mfma_f32_16x16x32_bf16 v[44:47], v[56:59], v[100:103], v[44:47]
    ds_read_b128 v[100:103], v173 offset:2560
    v_mfma_f32_16x16x32_bf16 v[40:43], v[56:59], v[96:99], v[40:43]
    s_waitcnt lgkmcnt(15)
    v_mfma_f32_16x16x32_bf16 v[44:47], v[60:63], v[96:99], v[44:47]
    ds_read_b128 v[96:99], v173 offset:2048
    s_waitcnt lgkmcnt(4)
    v_mfma_f32_16x16x32_bf16 v[28:31], v[48:51], v[92:95], v[28:31]
    v_mfma_f32_16x16x32_bf16 v[24:27], v[48:51], v[88:91], v[24:27]
    v_mfma_f32_16x16x32_bf16 v[20:23], v[48:51], v[84:87], v[20:23]
    v_mfma_f32_16x16x32_bf16 v[16:19], v[48:51], v[80:83], v[16:19]
    ds_read_b64 v[48:49], v172 offset:0
    v_mfma_f32_16x16x32_bf16 v[32:35], v[52:55], v[92:95], v[32:35]
    ds_read_b64 v[50:51], v172 offset:8
    buffer_load_dwordx4 v13, s[24:27], s40 offen offset:1024 lds
    v_mfma_f32_16x16x32_bf16 v[28:31], v[52:55], v[88:91], v[28:31]
    v_mfma_f32_16x16x32_bf16 v[24:27], v[52:55], v[84:87], v[24:27]
    v_mfma_f32_16x16x32_bf16 v[20:23], v[52:55], v[80:83], v[20:23]
    ds_read_b64 v[52:53], v172 offset:512
    v_mfma_f32_16x16x32_bf16 v[36:39], v[56:59], v[92:95], v[36:39]
    ds_read_b64 v[54:55], v172 offset:520
    v_mfma_f32_16x16x32_bf16 v[32:35], v[56:59], v[88:91], v[32:35]
    v_mfma_f32_16x16x32_bf16 v[28:31], v[56:59], v[84:87], v[28:31]
    s_add_u32 s39, s39, 8192
    s_add_u32 s40, s40, 110592
    v_mfma_f32_16x16x32_bf16 v[24:27], v[56:59], v[80:83], v[24:27]
    ds_read_b64 v[56:57], v172 offset:1024
    s_cmp_lt_u32 s40, 884736
    s_cselect_b32 s40, s40, 0
    s_cselect_b32 s39, s39, s63
    v_mfma_f32_16x16x32_bf16 v[40:43], v[60:63], v[92:95], v[40:43]
    ds_read_b64 v[58:59], v172 offset:1032
    s_add_u32 s69, s69, 1
    s_cmp_lt_u32 s69, 8
    v_mfma_f32_16x16x32_bf16 v[36:39], v[60:63], v[88:91], v[36:39]
    v_mfma_f32_16x16x32_bf16 v[32:35], v[60:63], v[84:87], v[32:35]
    v_mfma_f32_16x16x32_bf16 v[28:31], v[60:63], v[80:83], v[28:31]
    ds_read_b64 v[60:61], v172 offset:1536
    v_mfma_f32_16x16x32_bf16 v[44:47], v[76:79], v[80:83], v[44:47]
    ds_read_b64 v[62:63], v172 offset:1544
    v_mfma_f32_16x16x32_bf16 v[40:43], v[72:75], v[80:83], v[40:43]
    ds_read_b64 v[76:77], v172 offset:3584
    v_add_u32 v172, 64, v172
    v_subrev_u32 v173, 64, v173
    v_mfma_f32_16x16x32_bf16 v[36:39], v[68:71], v[80:83], v[36:39]
    ds_read_b64 v[78:79], v172 offset:3528
    v_mfma_f32_16x16x32_bf16 v[32:35], v[64:67], v[80:83], v[32:35]
    ds_read_b128 v[80:83], v173 offset:64
    v_mfma_f32_16x16x32_bf16 v[44:47], v[72:75], v[84:87], v[44:47]
    ds_read_b64 v[72:73], v172 offset:3008
    v_mfma_f32_16x16x32_bf16 v[40:43], v[68:71], v[84:87], v[40:43]
    ds_read_b64 v[74:75], v172 offset:3016
    v_mfma_f32_16x16x32_bf16 v[36:39], v[64:67], v[84:87], v[36:39]
    ds_read_b128 v[84:87], v173 offset:576
    v_mfma_f32_16x16x32_bf16 v[44:47], v[68:71], v[88:91], v[44:47]
    ds_read_b64 v[68:69], v172 offset:2496
    v_mfma_f32_16x16x32_bf16 v[40:43], v[64:67], v[88:91], v[40:43]
    ds_read_b64 v[70:71], v172 offset:2504
    v_mfma_f32_16x16x32_bf16 v[44:47], v[64:67], v[92:95], v[44:47]
    ds_read_b128 v[88:91], v173 offset:1088
    ds_read_b64 v[64:65], v172 offset:1984
    ds_read_b64 v[66:67], v172 offset:1992
    ds_read_b128 v[92:95], v173 offset:1600
    s_cbranch_scc1 L_p_27
    s_waitcnt lgkmcnt(0)
    v_lshlrev_b32 v83, 16, v112
    v_and_b32 v82, s35, v112
    v_lshlrev_b32 v81, 16, v113
    v_and_b32 v80, s35, v113
    v_pk_fma_f32 v[16:17], v[80:81], v[128:129], v[16:17]
    v_pk_fma_f32 v[18:19], v[82:83], v[128:129], v[18:19]
    v_cvt_pk_bf16_f32 v88, v16, v17
    v_cvt_pk_bf16_f32 v89, v18, v19
    ds_write_b64 v130, v[88:89] offset:0
    v_lshlrev_b32 v87, 16, v114
    v_and_b32 v86, s35, v114
    v_lshlrev_b32 v85, 16, v115
    v_and_b32 v84, s35, v115
    v_pk_fma_f32 v[20:21], v[84:85], v[128:129], v[20:21]
    v_pk_fma_f32 v[22:23], v[86:87], v[128:129], v[22:23]
    v_cvt_pk_bf16_f32 v90, v20, v21
    v_cvt_pk_bf16_f32 v91, v22, v23
    ds_write_b64 v130, v[90:91] offset:512
    v_lshlrev_b32 v83, 16, v116
    v_and_b32 v82, s35, v116
    v_lshlrev_b32 v81, 16, v117
    v_and_b32 v80, s35, v117
    v_pk_fma_f32 v[24:25], v[80:81], v[128:129], v[24:25]
    v_pk_fma_f32 v[26:27], v[82:83], v[128:129], v[26:27]
    v_cvt_pk_bf16_f32 v88, v24, v25
    v_cvt_pk_bf16_f32 v89, v26, v27
    ds_write_b64 v130, v[88:89] offset:1024
    v_lshlrev_b32 v87, 16, v118
    v_and_b32 v86, s35, v118
    v_lshlrev_b32 v85, 16, v119
    v_and_b32 v84, s35, v119
    v_pk_fma_f32 v[28:29], v[84:85], v[128:129], v[28:29]
    v_pk_fma_f32 v[30:31], v[86:87], v[128:129], v[30:31]
    v_cvt_pk_bf16_f32 v90, v28, v29
    v_cvt_pk_bf16_f32 v91, v30, v31
    ds_write_b64 v130, v[90:91] offset:1536
    v_lshlrev_b32 v83, 16, v120
    v_and_b32 v82, s35, v120
    v_lshlrev_b32 v81, 16, v121
    v_and_b32 v80, s35, v121
    v_pk_fma_f32 v[32:33], v[80:81], v[128:129], v[32:33]
    v_pk_fma_f32 v[34:35], v[82:83], v[128:129], v[34:35]
    v_cvt_pk_bf16_f32 v88, v32, v33
    v_cvt_pk_bf16_f32 v89, v34, v35
    ds_write_b64 v130, v[88:89] offset:2048
    v_lshlrev_b32 v87, 16, v122
    v_and_b32 v86, s35, v122
    v_lshlrev_b32 v85, 16, v123
    v_and_b32 v84, s35, v123
    v_pk_fma_f32 v[36:37], v[84:85], v[128:129], v[36:37]
    v_pk_fma_f32 v[38:39], v[86:87], v[128:129], v[38:39]
    v_cvt_pk_bf16_f32 v90, v36, v37
    v_cvt_pk_bf16_f32 v91, v38, v39
    ds_write_b64 v130, v[90:91] offset:2560
    v_lshlrev_b32 v83, 16, v124
    v_and_b32 v82, s35, v124
    v_lshlrev_b32 v81, 16, v125
    v_and_b32 v80, s35, v125
    v_pk_fma_f32 v[40:41], v[80:81], v[128:129], v[40:41]
    v_pk_fma_f32 v[42:43], v[82:83], v[128:129], v[42:43]
    v_cvt_pk_bf16_f32 v88, v40, v41
    v_cvt_pk_bf16_f32 v89, v42, v43
    ds_write_b64 v130, v[88:89] offset:3072
    v_lshlrev_b32 v87, 16, v126
    v_and_b32 v86, s35, v126
    v_lshlrev_b32 v85, 16, v127
    v_and_b32 v84, s35, v127
    v_pk_fma_f32 v[44:45], v[84:85], v[128:129], v[44:45]
    v_pk_fma_f32 v[46:47], v[86:87], v[128:129], v[46:47]
    v_cvt_pk_bf16_f32 v90, v44, v45
    v_cvt_pk_bf16_f32 v91, v46, v47
    ds_write_b64 v130, v[90:91] offset:3584
    s_waitcnt lgkmcnt(0)
    s_barrier
    ds_read_b128 v[140:143], v134 offset:0
    ds_read_b128 v[144:147], v134 offset:1024
    ds_read_b128 v[148:151], v134 offset:2048
    ds_read_b128 v[152:155], v134 offset:3072
    s_waitcnt lgkmcnt(3)
    s_mov_b32 s33, 0x300000
    buffer_store_dwordx4 v[140:143], v135, s[4:7], s33 offen sc1
    s_waitcnt lgkmcnt(2)
    s_mov_b32 s33, 0x3a0000
    buffer_store_dwordx4 v[144:147], v135, s[4:7], s33 offen sc1
    s_waitcnt lgkmcnt(1)
    s_mov_b32 s33, 0x440000
    buffer_store_dwordx4 v[148:151], v135, s[4:7], s33 offen sc1
    s_waitcnt lgkmcnt(0)
    s_mov_b32 s33, 0x4e0000
    buffer_store_dwordx4 v[152:155], v135, s[4:7], s33 offen sc1
    s_cmp_lg_u32 s30, 3
    s_cbranch_scc1 L_p_28
    v_mov_b32 v2, 78352
    v_mov_b32 v3, s31
    v_mov_b32 v4, s44
    v_mov_b32 v5, s32
    ds_write2_b32 v2, v3, v4 offset0:0 offset1:1
    ds_write_b32 v2, v5 offset:8
    s_waitcnt lgkmcnt(0)
    v_lshlrev_b32 v2, 4, v1
    v_add_u32 v2, 0x1600000, v2
    s_mov_b32 m0, 65536
    s_movk_i32 s33, 0
    buffer_load_dwordx4 v2, s[4:7], s33 offen offset:0 sc1 lds
    buffer_load_dwordx4 v2, s[4:7], s33 offen offset:1024 sc1 lds
    buffer_load_dwordx4 v2, s[4:7], s33 offen offset:2048 sc1 lds
    buffer_load_dwordx4 v2, s[4:7], s33 offen offset:3072 sc1 lds
    s_mov_b32 m0, 69632
    s_movk_i32 s33, 4096
    buffer_load_dwordx4 v2, s[4:7], s33 offen offset:0 sc1 lds
    buffer_load_dwordx4 v2, s[4:7], s33 offen offset:1024 sc1 lds
    buffer_load_dwordx4 v2, s[4:7], s33 offen offset:2048 sc1 lds
    buffer_load_dwordx4 v2, s[4:7], s33 offen offset:3072 sc1 lds
    s_mov_b32 m0, 73728
    s_movk_i32 s33, 8192
    buffer_load_dwordx4 v2, s[4:7], s33 offen offset:0 sc1 lds
    buffer_load_dwordx4 v2, s[4:7], s33 offen offset:1024 sc1 lds
    buffer_load_dwordx4 v2, s[4:7], s33 offen offset:2048 sc1 lds
    buffer_load_dwordx4 v2, s[4:7], s33 offen offset:3072 sc1 lds
    s_mov_b32 m0, 77824
    s_movk_i32 s33, 12288
    s_mov_b32 exec_lo, 0xffffffff
    s_mov_b32 exec_hi, 0
    buffer_load_dwordx4 v2, s[4:7], s33 offen offset:0 sc1 lds
    s_mov_b64 exec, -1
    s_waitcnt vmcnt(13)
    s_barrier
    s_lshl_b32 s33, s28, 10
    s_add_u32 s33, s33, 0x1780100
    s_lshl_b32 s34, s29, 2
    s_add_u32 s33, s33, s34
    v_mov_b32 v2, s33
    v_mov_b32 v3, s44
    s_mov_b32 exec_lo, 0x1
    s_mov_b32 exec_hi, 0
    s_cmp_lg_u32 s32, 0
    s_cbranch_scc1 L_p_30
    buffer_store_dword v3, v2, s[4:7], 0 offen
    s_branch L_p_31
L_p_30:
    buffer_wbl2 sc1
    s_waitcnt vmcnt(0)
    buffer_store_dword v3, v2, s[4:7], 0 offen sc1
L_p_31:
    s_mov_b64 exec, -1
    s_waitcnt vmcnt(0)
    s_branch L_p_29
L_p_28:
    s_waitcnt vmcnt(0)
    s_barrier
L_p_29:
    s_branch L_p_2
L_p_7:
    s_mov_b64 exec, s[26:27]
    s_cbranch_execz L_p_32
    s_cmp_lg_u32 s30, 3
    s_cbranch_scc1 L_p_33
    s_waitcnt vmcnt(9)
    s_branch L_p_34
L_p_33:
    s_waitcnt vmcnt(8)
L_p_34:
    v_lshlrev_b32 v62, 16, v54
    v_and_b32 v66, s35, v54
    v_lshlrev_b32 v70, 16, v55
    v_and_b32 v74, s35, v55
    v_lshlrev_b32 v63, 16, v56
    v_and_b32 v67, s35, v56
    v_lshlrev_b32 v71, 16, v57
    v_and_b32 v75, s35, v57
    v_lshlrev_b32 v64, 16, v58
    v_and_b32 v68, s35, v58
    v_lshlrev_b32 v72, 16, v59
    v_and_b32 v76, s35, v59
    v_lshlrev_b32 v65, 16, v60
    v_and_b32 v69, s35, v60
    v_lshlrev_b32 v73, 16, v61
    v_and_b32 v77, s35, v61
    v_lshlrev_b32 v78, 16, v16
    v_and_b32 v79, s35, v16
    v_lshlrev_b32 v80, 16, v17
    v_and_b32 v81, s35, v17
    v_lshlrev_b32 v82, 16, v18
    v_and_b32 v83, s35, v18
    v_lshlrev_b32 v84, 16, v19
    v_and_b32 v85, s35, v19
    v_lshlrev_b32 v86, 16, v20
    v_and_b32 v87, s35, v20
    v_lshlrev_b32 v88, 16, v21
    v_and_b32 v89, s35, v21
    v_lshlrev_b32 v90, 16, v22
    v_and_b32 v91, s35, v22
    v_lshlrev_b32 v92, 16, v23
    v_and_b32 v93, s35, v23
    v_lshlrev_b32 v94, 16, v24
    v_and_b32 v95, s35, v24
    v_lshlrev_b32 v96, 16, v25
    v_and_b32 v97, s35, v25
    v_lshlrev_b32 v98, 16, v26
    v_and_b32 v99, s35, v26
    v_lshlrev_b32 v100, 16, v27
    v_and_b32 v101, s35, v27
    v_lshlrev_b32 v102, 16, v28
    v_and_b32 v103, s35, v28
    v_lshlrev_b32 v104, 16, v29
    v_and_b32 v105, s35, v29
    v_lshlrev_b32 v106, 16, v30
    v_and_b32 v107, s35, v30
    v_lshlrev_b32 v108, 16, v31
    v_and_b32 v109, s35, v31
    v_lshlrev_b32 v110, 16, v32
    v_and_b32 v111, s35, v32
    v_lshlrev_b32 v112, 16, v33
    v_and_b32 v113, s35, v33
    v_lshlrev_b32 v114, 16, v34
    v_and_b32 v115, s35, v34
    v_lshlrev_b32 v116, 16, v35
    v_and_b32 v117, s35, v35
    v_lshlrev_b32 v118, 16, v36
    v_and_b32 v119, s35, v36
    v_lshlrev_b32 v120, 16, v37
    v_and_b32 v121, s35, v37
    v_pk_mul_f32 v[122:123], v[78:79], v[74:75]
    v_pk_mul_f32 v[124:125], v[80:81], v[76:77]
    v_pk_mul_f32 v[126:127], v[82:83], v[74:75]
    v_pk_mul_f32 v[128:129], v[84:85], v[76:77]
    v_pk_fma_f32 v[122:123], v[82:83], v[70:71], v[122:123]
    v_pk_fma_f32 v[124:125], v[84:85], v[72:73], v[124:125]
    v_pk_fma_f32 v[126:127], v[86:87], v[70:71], v[126:127]
    v_pk_fma_f32 v[128:129], v[88:89], v[72:73], v[128:129]
    v_pk_fma_f32 v[122:123], v[86:87], v[66:67], v[122:123]
    v_pk_fma_f32 v[124:125], v[88:89], v[68:69], v[124:125]
    v_pk_fma_f32 v[126:127], v[90:91], v[66:67], v[126:127]
    v_pk_fma_f32 v[128:129], v[92:93], v[68:69], v[128:129]
    v_pk_fma_f32 v[78:79], v[90:91], v[62:63], v[122:123]
    v_pk_fma_f32 v[80:81], v[92:93], v[64:65], v[124:125]
    v_pk_fma_f32 v[82:83], v[94:95], v[62:63], v[126:127]
    v_pk_fma_f32 v[84:85], v[96:97], v[64:65], v[128:129]
    v_pk_mul_f32 v[122:123], v[86:87], v[74:75]
    v_pk_mul_f32 v[124:125], v[88:89], v[76:77]
    v_pk_mul_f32 v[126:127], v[90:91], v[74:75]
    v_pk_mul_f32 v[128:129], v[92:93], v[76:77]
    v_pk_fma_f32 v[122:123], v[90:91], v[70:71], v[122:123]
    v_pk_fma_f32 v[124:125], v[92:93], v[72:73], v[124:125]
    v_pk_fma_f32 v[126:127], v[94:95], v[70:71], v[126:127]
    v_pk_fma_f32 v[128:129], v[96:97], v[72:73], v[128:129]
    v_pk_fma_f32 v[122:123], v[94:95], v[66:67], v[122:123]
    v_pk_fma_f32 v[124:125], v[96:97], v[68:69], v[124:125]
    v_pk_fma_f32 v[126:127], v[98:99], v[66:67], v[126:127]
    v_pk_fma_f32 v[128:129], v[100:101], v[68:69], v[128:129]
    v_pk_fma_f32 v[86:87], v[98:99], v[62:63], v[122:123]
    v_pk_fma_f32 v[88:89], v[100:101], v[64:65], v[124:125]
    v_pk_fma_f32 v[90:91], v[102:103], v[62:63], v[126:127]
    v_pk_fma_f32 v[92:93], v[104:105], v[64:65], v[128:129]
    v_pk_mul_f32 v[122:123], v[94:95], v[74:75]
    v_pk_mul_f32 v[124:125], v[96:97], v[76:77]
    v_pk_mul_f32 v[126:127], v[98:99], v[74:75]
    v_pk_mul_f32 v[128:129], v[100:101], v[76:77]
    v_pk_fma_f32 v[122:123], v[98:99], v[70:71], v[122:123]
    v_pk_fma_f32 v[124:125], v[100:101], v[72:73], v[124:125]
    v_pk_fma_f32 v[126:127], v[102:103], v[70:71], v[126:127]
    v_pk_fma_f32 v[128:129], v[104:105], v[72:73], v[128:129]
    v_pk_fma_f32 v[122:123], v[102:103], v[66:67], v[122:123]
    v_pk_fma_f32 v[124:125], v[104:105], v[68:69], v[124:125]
    v_pk_fma_f32 v[126:127], v[106:107], v[66:67], v[126:127]
    v_pk_fma_f32 v[128:129], v[108:109], v[68:69], v[128:129]
    v_pk_fma_f32 v[94:95], v[106:107], v[62:63], v[122:123]
    v_pk_fma_f32 v[96:97], v[108:109], v[64:65], v[124:125]
    v_pk_fma_f32 v[98:99], v[110:111], v[62:63], v[126:127]
    v_pk_fma_f32 v[100:101], v[112:113], v[64:65], v[128:129]
    v_pk_mul_f32 v[122:123], v[102:103], v[74:75]
    v_pk_mul_f32 v[124:125], v[104:105], v[76:77]
    v_pk_mul_f32 v[126:127], v[106:107], v[74:75]
    v_pk_mul_f32 v[128:129], v[108:109], v[76:77]
    v_pk_fma_f32 v[122:123], v[106:107], v[70:71], v[122:123]
    v_pk_fma_f32 v[124:125], v[108:109], v[72:73], v[124:125]
    v_pk_fma_f32 v[126:127], v[110:111], v[70:71], v[126:127]
    v_pk_fma_f32 v[128:129], v[112:113], v[72:73], v[128:129]
    v_pk_fma_f32 v[122:123], v[110:111], v[66:67], v[122:123]
    v_pk_fma_f32 v[124:125], v[112:113], v[68:69], v[124:125]
    v_pk_fma_f32 v[126:127], v[114:115], v[66:67], v[126:127]
    v_pk_fma_f32 v[128:129], v[116:117], v[68:69], v[128:129]
    v_pk_fma_f32 v[102:103], v[114:115], v[62:63], v[122:123]
    v_pk_fma_f32 v[104:105], v[116:117], v[64:65], v[124:125]
    v_pk_fma_f32 v[106:107], v[118:119], v[62:63], v[126:127]
    v_pk_fma_f32 v[108:109], v[120:121], v[64:65], v[128:129]
    s_cmp_lg_u32 s30, 3
    s_cbranch_scc1 L_p_35
    s_waitcnt vmcnt(1)
    s_branch L_p_36
L_p_35:
    s_waitcnt vmcnt(0)
L_p_36:
    v_lshlrev_b32 v122, 16, v38
    v_and_b32 v123, s35, v38
    v_lshlrev_b32 v124, 16, v39
    v_and_b32 v125, s35, v39
    v_pk_mul_f32 v[78:79], v[78:79], v[122:123]
    v_pk_mul_f32 v[80:81], v[80:81], v[124:125]
    v_lshlrev_b32 v126, 16, v40
    v_and_b32 v127, s35, v40
    v_lshlrev_b32 v128, 16, v41
    v_and_b32 v129, s35, v41
    v_pk_mul_f32 v[82:83], v[82:83], v[126:127]
    v_pk_mul_f32 v[84:85], v[84:85], v[128:129]
    v_lshlrev_b32 v130, 16, v42
    v_and_b32 v131, s35, v42
    v_lshlrev_b32 v132, 16, v43
    v_and_b32 v133, s35, v43
    v_pk_mul_f32 v[86:87], v[86:87], v[130:131]
    v_pk_mul_f32 v[88:89], v[88:89], v[132:133]
    v_lshlrev_b32 v134, 16, v44
    v_and_b32 v135, s35, v44
    v_lshlrev_b32 v136, 16, v45
    v_and_b32 v137, s35, v45
    v_pk_mul_f32 v[90:91], v[90:91], v[134:135]
    v_pk_mul_f32 v[92:93], v[92:93], v[136:137]
    v_lshlrev_b32 v122, 16, v46
    v_and_b32 v123, s35, v46
    v_lshlrev_b32 v124, 16, v47
    v_and_b32 v125, s35, v47
    v_pk_mul_f32 v[94:95], v[94:95], v[122:123]
    v_pk_mul_f32 v[96:97], v[96:97], v[124:125]
    v_lshlrev_b32 v126, 16, v48
    v_and_b32 v127, s35, v48
    v_lshlrev_b32 v128, 16, v49
    v_and_b32 v129, s35, v49
    v_pk_mul_f32 v[98:99], v[98:99], v[126:127]
    v_pk_mul_f32 v[100:101], v[100:101], v[128:129]
    v_lshlrev_b32 v130, 16, v50
    v_and_b32 v131, s35, v50
    v_lshlrev_b32 v132, 16, v51
    v_and_b32 v133, s35, v51
    v_pk_mul_f32 v[102:103], v[102:103], v[130:131]
    v_pk_mul_f32 v[104:105], v[104:105], v[132:133]
    v_lshlrev_b32 v134, 16, v52
    v_and_b32 v135, s35, v52
    v_lshlrev_b32 v136, 16, v53
    v_and_b32 v137, s35, v53
    v_pk_mul_f32 v[106:107], v[106:107], v[134:135]
    v_pk_mul_f32 v[108:109], v[108:109], v[136:137]
    s_movk_i32 s66, 4096
    s_movk_i32 s67, 8192
    s_movk_i32 s68, 12288
    v_cvt_pk_bf16_f32 v16, v106, v102
    v_cvt_pk_bf16_f32 v17, v98, v94
    v_cvt_pk_bf16_f32 v18, v90, v86
    v_cvt_pk_bf16_f32 v19, v82, v78
    buffer_store_dwordx4 v[16:19], v11, s[4:7], 0 offen
    v_cvt_pk_bf16_f32 v20, v107, v103
    v_cvt_pk_bf16_f32 v21, v99, v95
    v_cvt_pk_bf16_f32 v22, v91, v87
    v_cvt_pk_bf16_f32 v23, v83, v79
    buffer_store_dwordx4 v[20:23], v11, s[4:7], s66 offen
    v_cvt_pk_bf16_f32 v24, v108, v104
    v_cvt_pk_bf16_f32 v25, v100, v96
    v_cvt_pk_bf16_f32 v26, v92, v88
    v_cvt_pk_bf16_f32 v27, v84, v80
    buffer_store_dwordx4 v[24:27], v11, s[4:7], s67 offen
    v_cvt_pk_bf16_f32 v28, v109, v105
    v_cvt_pk_bf16_f32 v29, v101, v97
    v_cvt_pk_bf16_f32 v30, v93, v89
    v_cvt_pk_bf16_f32 v31, v85, v81
    buffer_store_dwordx4 v[28:31], v11, s[4:7], s68 offen
L_p_32:
    s_mov_b64 exec, -1
    s_cmp_lg_u32 s30, 3
    s_cbranch_scc1 L_p_37
    s_waitcnt vmcnt(4)
    s_cmp_lg_u32 s29, 23
    s_cbranch_scc1 L_p_38
    s_waitcnt vmcnt(0)
L_p_38:
    s_getreg_b32 s44, hwreg(HW_REG_XCC_ID, 0, 4)
    s_mov_b32 s32, 0
    v_readfirstlane_b32 s31, v4
    s_nop 0
    s_mul_i32 s31, s31, 0x9e3779b1
    s_add_u32 s31, s31, 0x7f4a7c15
    s_add_u32 s44, s44, s31
L_p_37:
    s_bitcmp1_b32 s30, 0
    s_cselect_b32 s0, s52, s50
    s_cselect_b32 s1, s53, s51
    s_mov_b32 s24, s0
    s_and_b32 s25, s1, 0xffff
    s_mov_b32 s26, 0x21c000
    s_mov_b32 s27, 0x20000
    v_lshrrev_b32 v14, 3, v1
    s_lshr_b32 s33, s30, 1
    s_lshl_b32 s34, s33, 4
    v_add_u32 v14, s34, v14
    v_mul_u32_u24 v14, 3456, v14
    v_bfe_u32 v15, v1, 1, 2
    v_lshrrev_b32 v13, 4, v1
    v_xor_b32 v15, v15, v13
    v_lshlrev_b32 v15, 5, v15
    v_and_b32 v13, 1, v1
    v_lshl_add_u32 v15, v13, 4, v15
    v_add_u32 v14, v14, v15
    s_sub_u32 s45, s29, 4
    s_add_u32 s34, s29, 7
    s_cmp_lt_u32 s29, 24
    s_cselect_b32 s45, s34, s45
    s_cmp_lt_u32 s29, 20
    s_cselect_b32 s45, s29, s45
    s_cmp_eq_u32 s29, 31
    s_cselect_b32 s45, s29, s45
    s_lshl_b32 s34, s45, 7
    v_add_u32 v12, s34, v14
    v_add_u32 v13, 26624, v12
    s_and_b32 s34, s30, 1
    s_lshl_b32 s34, s34, 12
    s_lshl_b32 s33, s33, 11
    s_add_u32 s63, s33, s34
    s_waitcnt vmcnt(0) lgkmcnt(0)
    s_barrier
    s_cmp_lg_u32 s30, 3
    s_cbranch_scc1 L_p_39
    s_lshl_b32 s33, s28, 10
    s_add_u32 s33, s33, 0x1780080
    s_lshl_b32 s34, s29, 2
    s_add_u32 s33, s33, s34
    v_mov_b32 v2, s33
    v_mov_b32 v3, s44
    s_mov_b32 exec_lo, 0x1
    s_mov_b32 exec_hi, 0
    s_cmp_lg_u32 s32, 0
    s_cbranch_scc1 L_p_40
    buffer_store_dword v3, v2, s[4:7], 0 offen
    s_branch L_p_41
L_p_40:
    buffer_wbl2 sc1
    s_waitcnt vmcnt(0)
    buffer_store_dword v3, v2, s[4:7], 0 offen sc1
L_p_41:
    s_mov_b64 exec, -1
L_p_39:
    s_lshl_b32 s62, s28, 2
    s_add_u32 s62, s62, s29
    s_sub_u32 s62, s62, 20
    s_mov_b32 s8, s54
    s_and_b32 s9, s55, 0xffff
    s_mov_b32 s10, 0x21c000
    s_mov_b32 s11, 0x20000
    s_mul_i32 s66, s30, 10240
    v_lshl_add_u32 v2, v1, 4, s66
    s_add_u32 s66, s66, 78848
    s_mov_b32 s69, s62
    s_mul_i32 s67, s69, 40960
    s_add_u32 m0, s66, 0
    s_add_u32 s33, s67, 0
    buffer_load_dwordx4 v2, s[8:11], s33 offen offset:0 lds
    buffer_load_dwordx4 v2, s[8:11], s33 offen offset:1024 lds
    buffer_load_dwordx4 v2, s[8:11], s33 offen offset:2048 lds
    buffer_load_dwordx4 v2, s[8:11], s33 offen offset:3072 lds
    s_add_u32 m0, s66, 4096
    s_add_u32 s33, s67, 4096
    buffer_load_dwordx4 v2, s[8:11], s33 offen offset:0 lds
    buffer_load_dwordx4 v2, s[8:11], s33 offen offset:1024 lds
    buffer_load_dwordx4 v2, s[8:11], s33 offen offset:2048 lds
    buffer_load_dwordx4 v2, s[8:11], s33 offen offset:3072 lds
    s_add_u32 m0, s66, 8192
    s_add_u32 s33, s67, 8192
    buffer_load_dwordx4 v2, s[8:11], s33 offen offset:0 lds
    buffer_load_dwordx4 v2, s[8:11], s33 offen offset:1024 lds
    s_mul_i32 s67, s69, 40960
    s_add_u32 s67, s67, 1310720
    s_add_u32 m0, s66, 40960
    s_add_u32 s33, s67, 0
    buffer_load_dwordx4 v2, s[8:11], s33 offen offset:0 lds
    buffer_load_dwordx4 v2, s[8:11], s33 offen offset:1024 lds
    buffer_load_dwordx4 v2, s[8:11], s33 offen offset:2048 lds
    buffer_load_dwordx4 v2, s[8:11], s33 offen offset:3072 lds
    s_add_u32 m0, s66, 45056
    s_add_u32 s33, s67, 4096
    buffer_load_dwordx4 v2, s[8:11], s33 offen offset:0 lds
    buffer_load_dwordx4 v2, s[8:11], s33 offen offset:1024 lds
    buffer_load_dwordx4 v2, s[8:11], s33 offen offset:2048 lds
    buffer_load_dwordx4 v2, s[8:11], s33 offen offset:3072 lds
    s_add_u32 m0, s66, 49152
    s_add_u32 s33, s67, 8192
    buffer_load_dwordx4 v2, s[8:11], s33 offen offset:0 lds
    buffer_load_dwordx4 v2, s[8:11], s33 offen offset:1024 lds
    s_lshl_b32 s33, s28, 5
    s_add_u32 s33, s33, s29
    s_mul_i32 s34, s30, 160
    v_and_b32 v2, 7, v1
    v_lshrrev_b32 v3, 3, v1
    v_lshl_add_u32 v4, v3, 2, s34
    s_lshl_b32 s66, s33, 3
    v_add_u32 v6, s66, v3
    v_mul_u32_u24 v6, 1280, v6
    v_lshl_add_u32 v6, v2, 3, v6
    s_lshl_b32 s66, s34, 1
    v_add_u32 v6, s66, v6
    v_lshlrev_b32 v15, 2, v4
    v_add_u32 v15, 65536, v15
    v_add_u32 v7, s34, v1
    v_lshlrev_b32 v7, 5, v7
    s_lshr_b32 s66, s33, 1
    s_and_b32 s67, s33, 1
    s_mul_i32 s68, s66, 20480
    s_lshl_b32 s33, s67, 4
    s_add_u32 s68, s68, s33
    s_add_u32 s68, s68, 0x300000
    v_add_u32 v7, s68, v7
    v_lshrrev_b32 v8, 4, v1
    v_lshlrev_b32 v8, 3, v8
    v_bfe_u32 v9, v1, 1, 1
    v_lshl_add_u32 v8, v9, 2, v8
    v_bfe_u32 v9, v1, 2, 2
    v_add_u32 v8, v8, v9
    v_lshlrev_b32 v8, 4, v8
    v_and_b32 v9, 1, v1
    v_lshl_add_u32 v8, v9, 3, v8
    s_mul_i32 s41, s30, 3072
    s_add_u32 s41, s41, 65536
    v_add_u32 v8, s41, v8
    v_lshlrev_b32 v10, 5, v2
    v_add_u32 v10, 78848, v10
    v_bfe_u32 v9, v1, 4, 1
    v_lshl_add_u32 v9, v9, 4, v10
    s_lshl_b32 s68, s30, 2
    v_add_u32 v9, s68, v9
    v_and_b32 v11, 3, v3
    v_lshlrev_b32 v11, 4, v11
    s_lshl_b32 s68, s67, 3
    v_add_u32 v11, s68, v11
    v_add_u32 v11, v11, v2
    v_lshlrev_b32 v11, 4, v11
    v_lshrrev_b32 v4, 2, v3
    v_lshl_add_u32 v11, v4, 3, v11
    s_mul_i32 s68, s66, 21
    s_mul_i32 s34, s30, 5
    s_add_u32 s68, s68, s34
    s_lshl_b32 s68, s68, 10
    s_add_u32 s68, s68, 0x600000
    v_add_u32 v11, s68, v11
    s_mov_b32 s8, s36
    s_and_b32 s9, s37, 0xffff
    s_mov_b32 s10, 0x280000
    s_mov_b32 s11, 0x20000
    buffer_load_dwordx2 v[240:241], v6, s[8:11], 0 offen offset:0
    buffer_load_dwordx2 v[242:243], v6, s[8:11], 0 offen offset:64
    buffer_load_dwordx2 v[244:245], v6, s[8:11], 0 offen offset:128
    buffer_load_dwordx2 v[246:247], v6, s[8:11], 0 offen offset:192
    buffer_load_dwordx2 v[248:249], v6, s[8:11], 0 offen offset:256
    s_cmp_lg_u32 s30, 3
    s_cbranch_scc1 L_p_42
    s_lshl_b32 s33, s28, 10
    s_add_u32 s33, s33, 0x1780080
    v_lshl_add_u32 v2, v1, 2, s33
    s_mov_b32 exec_lo, 0xffffffff
    s_mov_b32 exec_hi, 0
    s_mov_b32 s3, 40
L_p_43:
    buffer_load_dword v3, v2, s[4:7], 0 offen sc1
    s_sub_u32 s3, s3, 1
    s_waitcnt vmcnt(0)
    v_cmp_ne_u32 vcc, s44, v3
    s_cbranch_vccz L_p_46
    s_cmp_lg_u32 s3, 0
    s_cbranch_scc1 L_p_43
    s_lshl_b32 s33, s28, 10
    s_add_u32 s33, s33, 0x1780000
    s_lshl_b32 s34, s29, 2
    s_add_u32 s33, s33, s34
    v_mov_b32 v2, s33
    v_mov_b32 v3, s44
    s_mov_b32 exec_lo, 0x1
    s_mov_b32 exec_hi, 0
    buffer_store_dword v3, v2, s[4:7], 0 offen sc1
    s_mov_b64 exec, -1
    s_lshl_b32 s33, s28, 10
    s_add_u32 s33, s33, 0x1780080
    v_lshl_add_u32 v2, v1, 2, s33
    v_lshrrev_b32 v4, 5, v1
    v_mul_u32_u24 v4, 256, v4
    v_sub_u32 v2, v2, v4
    s_mov_b32 s3, 1048576
L_p_44:
    buffer_load_dword v3, v2, s[4:7], 0 offen sc1
    s_sub_u32 s3, s3, 1
    s_cmp_eq_u32 s3, 0
    s_cbranch_scc1 L_end
    s_waitcnt vmcnt(0)
    v_cmp_ne_u32 vcc, s44, v3
    v_subrev_u32 v4, s31, v3
    v_cmp_le_u32 s[0:1], 8, v4
    s_cmp_eq_u32 vcc_lo, 0
    s_cbranch_scc1 L_p_46
    s_cmp_lg_u32 s1, 0
    s_cbranch_scc1 L_p_44
    s_cmp_eq_u32 vcc_hi, 0
    s_cbranch_scc1 L_p_44
    s_mov_b32 s32, 1
    s_add_u32 s44, s31, 8
    s_lshl_b32 s33, s28, 10
    s_add_u32 s33, s33, 0x1780080
    s_lshl_b32 s34, s29, 2
    s_add_u32 s33, s33, s34
    v_mov_b32 v2, s33
    v_mov_b32 v3, s44
    s_mov_b32 exec_lo, 0x1
    s_mov_b32 exec_hi, 0
    s_cmp_lg_u32 s32, 0
    s_cbranch_scc1 L_p_47
    buffer_store_dword v3, v2, s[4:7], 0 offen
    s_branch L_p_48
L_p_47:
    buffer_wbl2 sc1
    s_waitcnt vmcnt(0)
    buffer_store_dword v3, v2, s[4:7], 0 offen sc1
L_p_48:
    s_mov_b64 exec, -1
L_p_46:
    s_mov_b64 exec, -1
L_p_42:
    s_waitcnt vmcnt(0) lgkmcnt(0)
    s_barrier
    v_lshrrev_b32 v7, 2, v1
    v_and_b32 v8, 3, v1
    v_mul_u32_u24 v7, 1280, v7
    s_mul_i32 s33, s30, 320
    s_add_u32 s33, s33, 78848
    v_add_u32 v7, s33, v7
    v_lshl_add_u32 v9, v8, 4, v7
    v_lshl_add_u32 v10, v8, 3, v7
    v_lshlrev_b32 v6, 4, v1
    ds_read_b64_tr_b16 v[16:17], v9 offset:0
    ds_read_b64_tr_b16 v[18:19], v9 offset:20480
    ds_read_b64_tr_b16 v[20:21], v9 offset:8
    ds_read_b64_tr_b16 v[22:23], v9 offset:20488
    ds_read_b64_tr_b16 v[24:25], v9 offset:64
    ds_read_b64_tr_b16 v[26:27], v9 offset:20544
    ds_read_b64_tr_b16 v[28:29], v9 offset:72
    ds_read_b64_tr_b16 v[30:31], v9 offset:20552
    ds_read_b64_tr_b16 v[32:33], v10 offset:128
    ds_read_b64_tr_b16 v[34:35], v10 offset:20608
    s_lshl_b32 s33, s30, 1
    s_add_u32 s33, s33, 0
    s_mul_i32 s33, s33, 54
    s_add_u32 s33, s33, s69
    s_mul_i32 s33, s33, 5120
    s_add_u32 s33, s33, 0x1300000
    s_waitcnt lgkmcnt(8)
    buffer_store_dwordx4 v[16:19], v6, s[4:7], s33 offen offset:0 sc1
    s_waitcnt lgkmcnt(6)
    buffer_store_dwordx4 v[20:23], v6, s[4:7], s33 offen offset:1024 sc1
    s_waitcnt lgkmcnt(4)
    buffer_store_dwordx4 v[24:27], v6, s[4:7], s33 offen offset:2048 sc1
    s_waitcnt lgkmcnt(2)
    buffer_store_dwordx4 v[28:31], v6, s[4:7], s33 offen offset:3072 sc1
    s_waitcnt lgkmcnt(0)
    s_add_u32 s33, s33, 4096
    buffer_store_dwordx4 v[32:35], v6, s[4:7], s33 offen offset:0 sc1
    ds_read_b64_tr_b16 v[36:37], v9 offset:160
    ds_read_b64_tr_b16 v[38:39], v9 offset:20640
    ds_read_b64_tr_b16 v[40:41], v9 offset:168
    ds_read_b64_tr_b16 v[42:43], v9 offset:20648
    ds_read_b64_tr_b16 v[44:45], v9 offset:224
    ds_read_b64_tr_b16 v[46:47], v9 offset:20704
    ds_read_b64_tr_b16 v[48:49], v9 offset:232
    ds_read_b64_tr_b16 v[50:51], v9 offset:20712
    ds_read_b64_tr_b16 v[52:53], v10 offset:288
    ds_read_b64_tr_b16 v[54:55], v10 offset:20768
    s_lshl_b32 s33, s30, 1
    s_add_u32 s33, s33, 1
    s_mul_i32 s33, s33, 54
    s_add_u32 s33, s33, s69
    s_mul_i32 s33, s33, 5120
    s_add_u32 s33, s33, 0x1300000
    s_waitcnt lgkmcnt(8)
    buffer_store_dwordx4 v[36:39], v6, s[4:7], s33 offen offset:0 sc1
    s_waitcnt lgkmcnt(6)
    buffer_store_dwordx4 v[40:43], v6, s[4:7], s33 offen offset:1024 sc1
    s_waitcnt lgkmcnt(4)
    buffer_store_dwordx4 v[44:47], v6, s[4:7], s33 offen offset:2048 sc1
    s_waitcnt lgkmcnt(2)
    buffer_store_dwordx4 v[48:51], v6, s[4:7], s33 offen offset:3072 sc1
    s_waitcnt lgkmcnt(0)
    s_add_u32 s33, s33, 4096
    buffer_store_dwordx4 v[52:55], v6, s[4:7], s33 offen offset:0 sc1
    s_cmp_ge_u32 s69, 22
    s_cbranch_scc1 L_p_49
    s_add_u32 s69, s69, 32
    v_add_u32 v9, 40960, v9
    v_add_u32 v10, 40960, v10
    ds_read_b64_tr_b16 v[56:57], v9 offset:0
    ds_read_b64_tr_b16 v[58:59], v9 offset:20480
    ds_read_b64_tr_b16 v[60:61], v9 offset:8
    ds_read_b64_tr_b16 v[62:63], v9 offset:20488
    ds_read_b64_tr_b16 v[64:65], v9 offset:64
    ds_read_b64_tr_b16 v[66:67], v9 offset:20544
    ds_read_b64_tr_b16 v[68:69], v9 offset:72
    ds_read_b64_tr_b16 v[70:71], v9 offset:20552
    ds_read_b64_tr_b16 v[72:73], v10 offset:128
    ds_read_b64_tr_b16 v[74:75], v10 offset:20608
    s_lshl_b32 s33, s30, 1
    s_add_u32 s33, s33, 0
    s_mul_i32 s33, s33, 54
    s_add_u32 s33, s33, s69
    s_mul_i32 s33, s33, 5120
    s_add_u32 s33, s33, 0x1300000
    s_waitcnt lgkmcnt(8)
    buffer_store_dwordx4 v[56:59], v6, s[4:7], s33 offen offset:0 sc1
    s_waitcnt lgkmcnt(6)
    buffer_store_dwordx4 v[60:63], v6, s[4:7], s33 offen offset:1024 sc1
    s_waitcnt lgkmcnt(4)
    buffer_store_dwordx4 v[64:67], v6, s[4:7], s33 offen offset:2048 sc1
    s_waitcnt lgkmcnt(2)
    buffer_store_dwordx4 v[68:71], v6, s[4:7], s33 offen offset:3072 sc1
    s_waitcnt lgkmcnt(0)
    s_add_u32 s33, s33, 4096
    buffer_store_dwordx4 v[72:75], v6, s[4:7], s33 offen offset:0 sc1
    ds_read_b64_tr_b16 v[76:77], v9 offset:160
    ds_read_b64_tr_b16 v[78:79], v9 offset:20640
    ds_read_b64_tr_b16 v[80:81], v9 offset:168
    ds_read_b64_tr_b16 v[82:83], v9 offset:20648
    ds_read_b64_tr_b16 v[84:85], v9 offset:224
    ds_read_b64_tr_b16 v[86:87], v9 offset:20704
    ds_read_b64_tr_b16 v[88:89], v9 offset:232
    ds_read_b64_tr_b16 v[90:91], v9 offset:20712
    ds_read_b64_tr_b16 v[92:93], v10 offset:288
    ds_read_b64_tr_b16 v[94:95], v10 offset:20768
    s_lshl_b32 s33, s30, 1
    s_add_u32 s33, s33, 1
    s_mul_i32 s33, s33, 54
    s_add_u32 s33, s33, s69
    s_mul_i32 s33, s33, 5120
    s_add_u32 s33, s33, 0x1300000
    s_waitcnt lgkmcnt(8)
    buffer_store_dwordx4 v[76:79], v6, s[4:7], s33 offen offset:0 sc1
    s_waitcnt lgkmcnt(6)
    buffer_store_dwordx4 v[80:83], v6, s[4:7], s33 offen offset:1024 sc1
    s_waitcnt lgkmcnt(4)
    buffer_store_dwordx4 v[84:87], v6, s[4:7], s33 offen offset:2048 sc1
    s_waitcnt lgkmcnt(2)
    buffer_store_dwordx4 v[88:91], v6, s[4:7], s33 offen offset:3072 sc1
    s_waitcnt lgkmcnt(0)
    s_add_u32 s33, s33, 4096
    buffer_store_dwordx4 v[92:95], v6, s[4:7], s33 offen offset:0 sc1
L_p_49:
    s_cmp_lg_u32 s30, 3
    s_cbranch_scc1 L_p_50
    v_mov_b32 v2, 78352
    v_mov_b32 v3, s31
    v_mov_b32 v4, s44
    v_mov_b32 v5, s32
    ds_write2_b32 v2, v3, v4 offset0:0 offset1:1
    ds_write_b32 v2, v5 offset:8
    s_waitcnt lgkmcnt(0)
    v_lshlrev_b32 v2, 4, v1
    v_add_u32 v2, 0x1600000, v2
    s_mov_b32 m0, 65536
    s_movk_i32 s33, 0
    buffer_load_dwordx4 v2, s[4:7], s33 offen offset:0 sc1 lds
    buffer_load_dwordx4 v2, s[4:7], s33 offen offset:1024 sc1 lds
    buffer_load_dwordx4 v2, s[4:7], s33 offen offset:2048 sc1 lds
    buffer_load_dwordx4 v2, s[4:7], s33 offen offset:3072 sc1 lds
    s_mov_b32 m0, 69632
    s_movk_i32 s33, 4096
    buffer_load_dwordx4 v2, s[4:7], s33 offen offset:0 sc1 lds
    buffer_load_dwordx4 v2, s[4:7], s33 offen offset:1024 sc1 lds
    buffer_load_dwordx4 v2, s[4:7], s33 offen offset:2048 sc1 lds
    buffer_load_dwordx4 v2, s[4:7], s33 offen offset:3072 sc1 lds
    s_mov_b32 m0, 73728
    s_movk_i32 s33, 8192
    buffer_load_dwordx4 v2, s[4:7], s33 offen offset:0 sc1 lds
    buffer_load_dwordx4 v2, s[4:7], s33 offen offset:1024 sc1 lds
    buffer_load_dwordx4 v2, s[4:7], s33 offen offset:2048 sc1 lds
    buffer_load_dwordx4 v2, s[4:7], s33 offen offset:3072 sc1 lds
    s_mov_b32 m0, 77824
    s_movk_i32 s33, 12288
    s_mov_b32 exec_lo, 0xffffffff
    s_mov_b32 exec_hi, 0
    buffer_load_dwordx4 v2, s[4:7], s33 offen offset:0 sc1 lds
    s_mov_b64 exec, -1
L_p_50:
    s_waitcnt vmcnt(0) lgkmcnt(0)
    s_barrier
    s_cmp_lg_u32 s30, 3
    s_cbranch_scc1 L_p_51
    s_lshl_b32 s33, s62, 2
    s_add_u32 s33, s33, 0x1784000
    v_lshl_add_u32 v2, v1, 7, s33
    v_mov_b32 v3, s31
    s_mov_b32 exec_lo, 0xff
    s_mov_b32 exec_hi, 0
    buffer_store_dword v3, v2, s[4:7], 0 offen sc1
    s_mov_b64 exec, -1
L_p_51:
    s_lshl_b32 s33, s28, 5
    s_add_u32 s33, s33, s29
    s_mul_i32 s34, s30, 160
    v_and_b32 v2, 7, v1
    v_lshrrev_b32 v3, 3, v1
    v_lshl_add_u32 v4, v3, 2, s34
    s_lshl_b32 s66, s33, 3
    v_add_u32 v6, s66, v3
    v_mul_u32_u24 v6, 1280, v6
    v_lshl_add_u32 v6, v2, 3, v6
    s_lshl_b32 s66, s34, 1
    v_add_u32 v6, s66, v6
    v_lshlrev_b32 v15, 2, v4
    v_add_u32 v15, 65536, v15
    v_add_u32 v7, s34, v1
    v_lshlrev_b32 v7, 5, v7
    s_lshr_b32 s66, s33, 1
    s_and_b32 s67, s33, 1
    s_mul_i32 s68, s66, 20480
    s_lshl_b32 s33, s67, 4
    s_add_u32 s68, s68, s33
    s_add_u32 s68, s68, 0x300000
    v_add_u32 v7, s68, v7
    v_lshrrev_b32 v8, 4, v1
    v_lshlrev_b32 v8, 3, v8
    v_bfe_u32 v9, v1, 1, 1
    v_lshl_add_u32 v8, v9, 2, v8
    v_bfe_u32 v9, v1, 2, 2
    v_add_u32 v8, v8, v9
    v_lshlrev_b32 v8, 4, v8
    v_and_b32 v9, 1, v1
    v_lshl_add_u32 v8, v9, 3, v8
    s_mul_i32 s41, s30, 3072
    s_add_u32 s41, s41, 65536
    v_add_u32 v8, s41, v8
    v_lshlrev_b32 v10, 5, v2
    v_add_u32 v10, 78848, v10
    v_bfe_u32 v9, v1, 4, 1
    v_lshl_add_u32 v9, v9, 4, v10
    s_lshl_b32 s68, s30, 2
    v_add_u32 v9, s68, v9
    v_and_b32 v11, 3, v3
    v_lshlrev_b32 v11, 4, v11
    s_lshl_b32 s68, s67, 3
    v_add_u32 v11, s68, v11
    v_add_u32 v11, v11, v2
    v_lshlrev_b32 v11, 4, v11
    v_lshrrev_b32 v4, 2, v3
    v_lshl_add_u32 v11, v4, 3, v11
    s_mul_i32 s68, s66, 21
    s_mul_i32 s34, s30, 5
    s_add_u32 s68, s68, s34
    s_lshl_b32 s68, s68, 10
    s_add_u32 s68, s68, 0x600000
    v_add_u32 v11, s68, v11
    s_mov_b32 s26, 0
    s_branch L_p_2
L_p_4:
    buffer_load_dword v4, v3, s[4:7], 0 offen sc1
    s_lshl_b32 s62, s28, 3
    s_add_u32 s62, s62, s29
    s_sub_u32 s62, s62, 24
    s_mov_b32 s20, s44
    s_and_b32 s21, s45, 0xffff
    s_mov_b32 s22, 0x280000
    s_mov_b32 s23, 0x20000
    s_mul_i32 s33, s28, 327680
    s_sub_u32 s34, s29, 24
    s_mul_i32 s34, s34, 40960
    s_add_u32 s33, s33, s34
    v_lshl_add_u32 v5, v0, 7, s33
    v_add_u32 v6, 32768, v5
    s_waitcnt vmcnt(0)
    buffer_load_dword v20, v5, s[4:7], 0 offen sc1
    s_cmp_lg_u32 s30, 0
    s_cbranch_scc1 L_p_52
    buffer_load_dword v22, v6, s[4:7], 0 offen sc1
L_p_52:
    s_getreg_b32 s44, hwreg(HW_REG_XCC_ID, 0, 4)
    s_mov_b32 s32, 0
    v_readfirstlane_b32 s31, v4
    s_nop 0
    s_mul_i32 s31, s31, 0x9e3779b1
    s_add_u32 s31, s31, 0x7f4a7c15
    s_add_u32 s44, s44, s31
    s_cmp_lg_u32 s30, 3
    s_cbranch_scc1 L_p_53
    s_lshl_b32 s33, s28, 10
    s_add_u32 s33, s33, 0x1780080
    s_lshl_b32 s34, s29, 2
    s_add_u32 s33, s33, s34
    v_mov_b32 v2, s33
    v_mov_b32 v3, s44
    s_mov_b32 exec_lo, 0x1
    s_mov_b32 exec_hi, 0
    s_cmp_lg_u32 s32, 0
    s_cbranch_scc1 L_p_54
    buffer_store_dword v3, v2, s[4:7], 0 offen
    s_branch L_p_55
L_p_54:
    buffer_wbl2 sc1
    s_waitcnt vmcnt(0)
    buffer_store_dword v3, v2, s[4:7], 0 offen sc1
L_p_55:
    s_mov_b64 exec, -1
L_p_53:
    s_bitcmp1_b32 s30, 0
    s_cselect_b32 s0, s52, s50
    s_cselect_b32 s1, s53, s51
    s_mov_b32 s24, s0
    s_and_b32 s25, s1, 0xffff
    s_mov_b32 s26, 0x21c000
    s_mov_b32 s27, 0x20000
    v_lshrrev_b32 v14, 3, v1
    s_lshr_b32 s33, s30, 1
    s_lshl_b32 s34, s33, 4
    v_add_u32 v14, s34, v14
    v_mul_u32_u24 v14, 3456, v14
    v_bfe_u32 v15, v1, 1, 2
    v_lshrrev_b32 v13, 4, v1
    v_xor_b32 v15, v15, v13
    v_lshlrev_b32 v15, 5, v15
    v_and_b32 v13, 1, v1
    v_lshl_add_u32 v15, v13, 4, v15
    v_add_u32 v14, v14, v15
    s_sub_u32 s45, s29, 4
    s_add_u32 s34, s29, 7
    s_cmp_lt_u32 s29, 24
    s_cselect_b32 s45, s34, s45
    s_cmp_lt_u32 s29, 20
    s_cselect_b32 s45, s29, s45
    s_cmp_eq_u32 s29, 31
    s_cselect_b32 s45, s29, s45
    s_lshl_b32 s34, s45, 7
    v_add_u32 v12, s34, v14
    v_add_u32 v13, 26624, v12
    s_and_b32 s34, s30, 1
    s_lshl_b32 s34, s34, 12
    s_lshl_b32 s33, s33, 11
    s_add_u32 s63, s33, s34
    s_mov_b32 s8, s56
    s_and_b32 s9, s57, 0xffff
    s_mov_b32 s10, 0x500
    s_mov_b32 s11, 0x20000
    s_mov_b32 s12, s58
    s_and_b32 s13, s59, 0xffff
    s_mov_b32 s14, 0x4b0000
    s_mov_b32 s15, 0x20000
    v_and_b32 v2, 7, v0
    v_lshrrev_b32 v3, 3, v0
    v_mul_u32_u24 v4, 0x25800, v3
    v_lshl_add_u32 v4, v2, 4, v4
    s_lshl_b32 s33, s62, 7
    v_add_u32 v4, s33, v4
    v_lshlrev_b32 v5, 3, v0
    buffer_load_dwordx2 v[224:225], v5, s[8:11], 0 offen
    s_mov_b32 s33, 0
    buffer_load_dwordx4 v[140:143], v4, s[12:15], s33 offen
    s_mov_b32 s33, 7680
    buffer_load_dwordx4 v[144:147], v4, s[12:15], s33 offen
    s_mov_b32 s33, 15360
    buffer_load_dwordx4 v[148:151], v4, s[12:15], s33 offen
    s_mov_b32 s33, 23040
    buffer_load_dwordx4 v[152:155], v4, s[12:15], s33 offen
    s_mov_b32 s33, 30720
    buffer_load_dwordx4 v[156:159], v4, s[12:15], s33 offen
    s_mov_b32 s33, 38400
    buffer_load_dwordx4 v[160:163], v4, s[12:15], s33 offen
    s_mov_b32 s33, 46080
    buffer_load_dwordx4 v[164:167], v4, s[12:15], s33 offen
    s_mov_b32 s33, 53760
    buffer_load_dwordx4 v[168:171], v4, s[12:15], s33 offen
    s_mov_b32 s33, 61440
    buffer_load_dwordx4 v[172:175], v4, s[12:15], s33 offen
    s_mov_b32 s33, 69120
    buffer_load_dwordx4 v[176:179], v4, s[12:15], s33 offen
    s_mov_b32 s33, 76800
    buffer_load_dwordx4 v[180:183], v4, s[12:15], s33 offen
    s_mov_b32 s33, 84480
    buffer_load_dwordx4 v[184:187], v4, s[12:15], s33 offen
    s_mov_b32 s33, 92160
    buffer_load_dwordx4 v[188:191], v4, s[12:15], s33 offen
    s_mov_b32 s33, 99840
    buffer_load_dwordx4 v[192:195], v4, s[12:15], s33 offen
    s_mov_b32 s33, 107520
    buffer_load_dwordx4 v[196:199], v4, s[12:15], s33 offen
    s_mov_b32 s33, 115200
    buffer_load_dwordx4 v[200:203], v4, s[12:15], s33 offen
    s_mov_b32 s33, 122880
    buffer_load_dwordx4 v[204:207], v4, s[12:15], s33 offen
    s_mov_b32 s33, 130560
    buffer_load_dwordx4 v[208:211], v4, s[12:15], s33 offen
    s_mov_b32 s33, 138240
    buffer_load_dwordx4 v[212:215], v4, s[12:15], s33 offen
    s_mov_b32 s33, 145920
    buffer_load_dwordx4 v[216:219], v4, s[12:15], s33 offen
    s_lshl_b32 s33, s28, 5
    s_add_u32 s33, s33, s29
    s_mul_i32 s34, s30, 160
    v_and_b32 v2, 7, v1
    v_lshrrev_b32 v3, 3, v1
    v_lshl_add_u32 v4, v3, 2, s34
    s_lshl_b32 s66, s33, 3
    v_add_u32 v6, s66, v3
    v_mul_u32_u24 v6, 1280, v6
    v_lshl_add_u32 v6, v2, 3, v6
    s_lshl_b32 s66, s34, 1
    v_add_u32 v6, s66, v6
    v_lshlrev_b32 v15, 2, v4
    v_add_u32 v15, 65536, v15
    v_add_u32 v7, s34, v1
    v_lshlrev_b32 v7, 5, v7
    s_lshr_b32 s66, s33, 1
    s_and_b32 s67, s33, 1
    s_mul_i32 s68, s66, 20480
    s_lshl_b32 s33, s67, 4
    s_add_u32 s68, s68, s33
    s_add_u32 s68, s68, 0x300000
    v_add_u32 v7, s68, v7
    v_lshrrev_b32 v8, 4, v1
    v_lshlrev_b32 v8, 3, v8
    v_bfe_u32 v9, v1, 1, 1
    v_lshl_add_u32 v8, v9, 2, v8
    v_bfe_u32 v9, v1, 2, 2
    v_add_u32 v8, v8, v9
    v_lshlrev_b32 v8, 4, v8
    v_and_b32 v9, 1, v1
    v_lshl_add_u32 v8, v9, 3, v8
    s_mul_i32 s41, s30, 3072
    s_add_u32 s41, s41, 65536
    v_add_u32 v8, s41, v8
    v_lshlrev_b32 v10, 5, v2
    v_add_u32 v10, 78848, v10
    v_bfe_u32 v9, v1, 4, 1
    v_lshl_add_u32 v9, v9, 4, v10
    s_lshl_b32 s68, s30, 2
    v_add_u32 v9, s68, v9
    v_and_b32 v11, 3, v3
    v_lshlrev_b32 v11, 4, v11
    s_lshl_b32 s68, s67, 3
    v_add_u32 v11, s68, v11
    v_add_u32 v11, v11, v2
    v_lshlrev_b32 v11, 4, v11
    v_lshrrev_b32 v4, 2, v3
    v_lshl_add_u32 v11, v4, 3, v11
    s_mul_i32 s68, s66, 21
    s_mul_i32 s34, s30, 5
    s_add_u32 s68, s68, s34
    s_lshl_b32 s68, s68, 10
    s_add_u32 s68, s68, 0x600000
    v_add_u32 v11, s68, v11
    s_mov_b32 s16, s36
    s_and_b32 s17, s37, 0xffff
    s_mov_b32 s18, 0x280000
    s_mov_b32 s19, 0x20000
    buffer_load_dwordx2 v[240:241], v6, s[16:19], 0 offen offset:0
    buffer_load_dwordx2 v[242:243], v6, s[16:19], 0 offen offset:64
    buffer_load_dwordx2 v[244:245], v6, s[16:19], 0 offen offset:128
    buffer_load_dwordx2 v[246:247], v6, s[16:19], 0 offen offset:192
    buffer_load_dwordx2 v[248:249], v6, s[16:19], 0 offen offset:256
    s_cmp_ge_u32 s62, 60
    s_cbranch_scc1 L_p_56
    s_waitcnt vmcnt(25)
    v_lshlrev_b32 v8, 16, v224
    v_and_b32 v9, s35, v224
    v_lshlrev_b32 v10, 16, v225
    v_and_b32 v11, s35, v225
    v_mul_f32 v44, 0xbfb8aa3b, v8
    v_mul_f32 v45, 0xbfb8aa3b, v9
    v_mul_f32 v46, 0xbfb8aa3b, v10
    v_mul_f32 v47, 0xbfb8aa3b, v11
    v_exp_f32 v44, v44
    v_exp_f32 v45, v45
    v_exp_f32 v46, v46
    v_exp_f32 v47, v47
    v_add_f32 v44, 1.0, v44
    v_add_f32 v45, 1.0, v45
    v_add_f32 v46, 1.0, v46
    v_add_f32 v47, 1.0, v47
    v_rcp_f32 v44, v44
    v_rcp_f32 v45, v45
    v_rcp_f32 v46, v46
    v_rcp_f32 v47, v47
    v_mul_f32 v44, v44, v8
    v_mul_f32 v45, v45, v9
    v_mul_f32 v46, v46, v10
    v_mul_f32 v47, v47, v11
    v_cvt_pk_bf16_f32 v8, v44, v45
    v_cvt_pk_bf16_f32 v9, v46, v47
    v_lshlrev_b32 v44, 16, v8
    v_and_b32 v45, s35, v8
    v_lshlrev_b32 v46, 16, v9
    v_and_b32 v47, s35, v9
    v_lshlrev_b32 v6, 4, v0
    v_add_u32 v6, 119808, v6
    ds_write_b128 v6, v[44:47]
    s_waitcnt lgkmcnt(0)
    s_barrier
    v_lshrrev_b32 v7, 3, v0
    v_mul_u32_u24 v6, 80, v7
    v_add_u32 v6, 119808, v6
    ds_read_b128 v[16:19], v6 offset:0
    ds_read_b128 v[20:23], v6 offset:16
    ds_read_b128 v[24:27], v6 offset:32
    ds_read_b128 v[28:31], v6 offset:48
    ds_read_b128 v[32:35], v6 offset:64
    s_waitcnt lgkmcnt(0)
    s_waitcnt vmcnt(24)
    v_lshlrev_b32 v44, 16, v140
    v_and_b32 v45, s35, v140
    v_lshlrev_b32 v46, 16, v141
    v_and_b32 v47, s35, v141
    v_lshlrev_b32 v48, 16, v142
    v_and_b32 v49, s35, v142
    v_lshlrev_b32 v50, 16, v143
    v_and_b32 v51, s35, v143
    v_pk_mul_f32 v[36:37], v[44:45], v[16:17] op_sel_hi:[1,0]
    v_pk_mul_f32 v[38:39], v[46:47], v[16:17] op_sel_hi:[1,0]
    v_pk_mul_f32 v[40:41], v[48:49], v[16:17] op_sel_hi:[1,0]
    v_pk_mul_f32 v[42:43], v[50:51], v[16:17] op_sel_hi:[1,0]
    s_waitcnt vmcnt(23)
    v_lshlrev_b32 v44, 16, v144
    v_and_b32 v45, s35, v144
    v_lshlrev_b32 v46, 16, v145
    v_and_b32 v47, s35, v145
    v_lshlrev_b32 v48, 16, v146
    v_and_b32 v49, s35, v146
    v_lshlrev_b32 v50, 16, v147
    v_and_b32 v51, s35, v147
    v_pk_fma_f32 v[36:37], v[44:45], v[16:17], v[36:37] op_sel:[0,1,0] op_sel_hi:[1,1,1]
    v_pk_fma_f32 v[38:39], v[46:47], v[16:17], v[38:39] op_sel:[0,1,0] op_sel_hi:[1,1,1]
    v_pk_fma_f32 v[40:41], v[48:49], v[16:17], v[40:41] op_sel:[0,1,0] op_sel_hi:[1,1,1]
    v_pk_fma_f32 v[42:43], v[50:51], v[16:17], v[42:43] op_sel:[0,1,0] op_sel_hi:[1,1,1]
    s_waitcnt vmcnt(22)
    v_lshlrev_b32 v44, 16, v148
    v_and_b32 v45, s35, v148
    v_lshlrev_b32 v46, 16, v149
    v_and_b32 v47, s35, v149
    v_lshlrev_b32 v48, 16, v150
    v_and_b32 v49, s35, v150
    v_lshlrev_b32 v50, 16, v151
    v_and_b32 v51, s35, v151
    v_pk_fma_f32 v[36:37], v[44:45], v[18:19], v[36:37] op_sel_hi:[1,0,1]
    v_pk_fma_f32 v[38:39], v[46:47], v[18:19], v[38:39] op_sel_hi:[1,0,1]
    v_pk_fma_f32 v[40:41], v[48:49], v[18:19], v[40:41] op_sel_hi:[1,0,1]
    v_pk_fma_f32 v[42:43], v[50:51], v[18:19], v[42:43] op_sel_hi:[1,0,1]
    s_waitcnt vmcnt(21)
    v_lshlrev_b32 v44, 16, v152
    v_and_b32 v45, s35, v152
    v_lshlrev_b32 v46, 16, v153
    v_and_b32 v47, s35, v153
    v_lshlrev_b32 v48, 16, v154
    v_and_b32 v49, s35, v154
    v_lshlrev_b32 v50, 16, v155
    v_and_b32 v51, s35, v155
    v_pk_fma_f32 v[36:37], v[44:45], v[18:19], v[36:37] op_sel:[0,1,0] op_sel_hi:[1,1,1]
    v_pk_fma_f32 v[38:39], v[46:47], v[18:19], v[38:39] op_sel:[0,1,0] op_sel_hi:[1,1,1]
    v_pk_fma_f32 v[40:41], v[48:49], v[18:19], v[40:41] op_sel:[0,1,0] op_sel_hi:[1,1,1]
    v_pk_fma_f32 v[42:43], v[50:51], v[18:19], v[42:43] op_sel:[0,1,0] op_sel_hi:[1,1,1]
    s_waitcnt vmcnt(20)
    v_lshlrev_b32 v44, 16, v156
    v_and_b32 v45, s35, v156
    v_lshlrev_b32 v46, 16, v157
    v_and_b32 v47, s35, v157
    v_lshlrev_b32 v48, 16, v158
    v_and_b32 v49, s35, v158
    v_lshlrev_b32 v50, 16, v159
    v_and_b32 v51, s35, v159
    v_pk_fma_f32 v[36:37], v[44:45], v[20:21], v[36:37] op_sel_hi:[1,0,1]
    v_pk_fma_f32 v[38:39], v[46:47], v[20:21], v[38:39] op_sel_hi:[1,0,1]
    v_pk_fma_f32 v[40:41], v[48:49], v[20:21], v[40:41] op_sel_hi:[1,0,1]
    v_pk_fma_f32 v[42:43], v[50:51], v[20:21], v[42:43] op_sel_hi:[1,0,1]
    s_waitcnt vmcnt(19)
    v_lshlrev_b32 v44, 16, v160
    v_and_b32 v45, s35, v160
    v_lshlrev_b32 v46, 16, v161
    v_and_b32 v47, s35, v161
    v_lshlrev_b32 v48, 16, v162
    v_and_b32 v49, s35, v162
    v_lshlrev_b32 v50, 16, v163
    v_and_b32 v51, s35, v163
    v_pk_fma_f32 v[36:37], v[44:45], v[20:21], v[36:37] op_sel:[0,1,0] op_sel_hi:[1,1,1]
    v_pk_fma_f32 v[38:39], v[46:47], v[20:21], v[38:39] op_sel:[0,1,0] op_sel_hi:[1,1,1]
    v_pk_fma_f32 v[40:41], v[48:49], v[20:21], v[40:41] op_sel:[0,1,0] op_sel_hi:[1,1,1]
    v_pk_fma_f32 v[42:43], v[50:51], v[20:21], v[42:43] op_sel:[0,1,0] op_sel_hi:[1,1,1]
    s_waitcnt vmcnt(18)
    v_lshlrev_b32 v44, 16, v164
    v_and_b32 v45, s35, v164
    v_lshlrev_b32 v46, 16, v165
    v_and_b32 v47, s35, v165
    v_lshlrev_b32 v48, 16, v166
    v_and_b32 v49, s35, v166
    v_lshlrev_b32 v50, 16, v167
    v_and_b32 v51, s35, v167
    v_pk_fma_f32 v[36:37], v[44:45], v[22:23], v[36:37] op_sel_hi:[1,0,1]
    v_pk_fma_f32 v[38:39], v[46:47], v[22:23], v[38:39] op_sel_hi:[1,0,1]
    v_pk_fma_f32 v[40:41], v[48:49], v[22:23], v[40:41] op_sel_hi:[1,0,1]
    v_pk_fma_f32 v[42:43], v[50:51], v[22:23], v[42:43] op_sel_hi:[1,0,1]
    s_waitcnt vmcnt(17)
    v_lshlrev_b32 v44, 16, v168
    v_and_b32 v45, s35, v168
    v_lshlrev_b32 v46, 16, v169
    v_and_b32 v47, s35, v169
    v_lshlrev_b32 v48, 16, v170
    v_and_b32 v49, s35, v170
    v_lshlrev_b32 v50, 16, v171
    v_and_b32 v51, s35, v171
    v_pk_fma_f32 v[36:37], v[44:45], v[22:23], v[36:37] op_sel:[0,1,0] op_sel_hi:[1,1,1]
    v_pk_fma_f32 v[38:39], v[46:47], v[22:23], v[38:39] op_sel:[0,1,0] op_sel_hi:[1,1,1]
    v_pk_fma_f32 v[40:41], v[48:49], v[22:23], v[40:41] op_sel:[0,1,0] op_sel_hi:[1,1,1]
    v_pk_fma_f32 v[42:43], v[50:51], v[22:23], v[42:43] op_sel:[0,1,0] op_sel_hi:[1,1,1]
    s_waitcnt vmcnt(16)
    v_lshlrev_b32 v44, 16, v172
    v_and_b32 v45, s35, v172
    v_lshlrev_b32 v46, 16, v173
    v_and_b32 v47, s35, v173
    v_lshlrev_b32 v48, 16, v174
    v_and_b32 v49, s35, v174
    v_lshlrev_b32 v50, 16, v175
    v_and_b32 v51, s35, v175
    v_pk_fma_f32 v[36:37], v[44:45], v[24:25], v[36:37] op_sel_hi:[1,0,1]
    v_pk_fma_f32 v[38:39], v[46:47], v[24:25], v[38:39] op_sel_hi:[1,0,1]
    v_pk_fma_f32 v[40:41], v[48:49], v[24:25], v[40:41] op_sel_hi:[1,0,1]
    v_pk_fma_f32 v[42:43], v[50:51], v[24:25], v[42:43] op_sel_hi:[1,0,1]
    s_waitcnt vmcnt(15)
    v_lshlrev_b32 v44, 16, v176
    v_and_b32 v45, s35, v176
    v_lshlrev_b32 v46, 16, v177
    v_and_b32 v47, s35, v177
    v_lshlrev_b32 v48, 16, v178
    v_and_b32 v49, s35, v178
    v_lshlrev_b32 v50, 16, v179
    v_and_b32 v51, s35, v179
    v_pk_fma_f32 v[36:37], v[44:45], v[24:25], v[36:37] op_sel:[0,1,0] op_sel_hi:[1,1,1]
    v_pk_fma_f32 v[38:39], v[46:47], v[24:25], v[38:39] op_sel:[0,1,0] op_sel_hi:[1,1,1]
    v_pk_fma_f32 v[40:41], v[48:49], v[24:25], v[40:41] op_sel:[0,1,0] op_sel_hi:[1,1,1]
    v_pk_fma_f32 v[42:43], v[50:51], v[24:25], v[42:43] op_sel:[0,1,0] op_sel_hi:[1,1,1]
    s_waitcnt vmcnt(14)
    v_lshlrev_b32 v44, 16, v180
    v_and_b32 v45, s35, v180
    v_lshlrev_b32 v46, 16, v181
    v_and_b32 v47, s35, v181
    v_lshlrev_b32 v48, 16, v182
    v_and_b32 v49, s35, v182
    v_lshlrev_b32 v50, 16, v183
    v_and_b32 v51, s35, v183
    v_pk_fma_f32 v[36:37], v[44:45], v[26:27], v[36:37] op_sel_hi:[1,0,1]
    v_pk_fma_f32 v[38:39], v[46:47], v[26:27], v[38:39] op_sel_hi:[1,0,1]
    v_pk_fma_f32 v[40:41], v[48:49], v[26:27], v[40:41] op_sel_hi:[1,0,1]
    v_pk_fma_f32 v[42:43], v[50:51], v[26:27], v[42:43] op_sel_hi:[1,0,1]
    s_waitcnt vmcnt(13)
    v_lshlrev_b32 v44, 16, v184
    v_and_b32 v45, s35, v184
    v_lshlrev_b32 v46, 16, v185
    v_and_b32 v47, s35, v185
    v_lshlrev_b32 v48, 16, v186
    v_and_b32 v49, s35, v186
    v_lshlrev_b32 v50, 16, v187
    v_and_b32 v51, s35, v187
    v_pk_fma_f32 v[36:37], v[44:45], v[26:27], v[36:37] op_sel:[0,1,0] op_sel_hi:[1,1,1]
    v_pk_fma_f32 v[38:39], v[46:47], v[26:27], v[38:39] op_sel:[0,1,0] op_sel_hi:[1,1,1]
    v_pk_fma_f32 v[40:41], v[48:49], v[26:27], v[40:41] op_sel:[0,1,0] op_sel_hi:[1,1,1]
    v_pk_fma_f32 v[42:43], v[50:51], v[26:27], v[42:43] op_sel:[0,1,0] op_sel_hi:[1,1,1]
    s_waitcnt vmcnt(12)
    v_lshlrev_b32 v44, 16, v188
    v_and_b32 v45, s35, v188
    v_lshlrev_b32 v46, 16, v189
    v_and_b32 v47, s35, v189
    v_lshlrev_b32 v48, 16, v190
    v_and_b32 v49, s35, v190
    v_lshlrev_b32 v50, 16, v191
    v_and_b32 v51, s35, v191
    v_pk_fma_f32 v[36:37], v[44:45], v[28:29], v[36:37] op_sel_hi:[1,0,1]
    v_pk_fma_f32 v[38:39], v[46:47], v[28:29], v[38:39] op_sel_hi:[1,0,1]
    v_pk_fma_f32 v[40:41], v[48:49], v[28:29], v[40:41] op_sel_hi:[1,0,1]
    v_pk_fma_f32 v[42:43], v[50:51], v[28:29], v[42:43] op_sel_hi:[1,0,1]
    s_waitcnt vmcnt(11)
    v_lshlrev_b32 v44, 16, v192
    v_and_b32 v45, s35, v192
    v_lshlrev_b32 v46, 16, v193
    v_and_b32 v47, s35, v193
    v_lshlrev_b32 v48, 16, v194
    v_and_b32 v49, s35, v194
    v_lshlrev_b32 v50, 16, v195
    v_and_b32 v51, s35, v195
    v_pk_fma_f32 v[36:37], v[44:45], v[28:29], v[36:37] op_sel:[0,1,0] op_sel_hi:[1,1,1]
    v_pk_fma_f32 v[38:39], v[46:47], v[28:29], v[38:39] op_sel:[0,1,0] op_sel_hi:[1,1,1]
    v_pk_fma_f32 v[40:41], v[48:49], v[28:29], v[40:41] op_sel:[0,1,0] op_sel_hi:[1,1,1]
    v_pk_fma_f32 v[42:43], v[50:51], v[28:29], v[42:43] op_sel:[0,1,0] op_sel_hi:[1,1,1]
    s_waitcnt vmcnt(10)
    v_lshlrev_b32 v44, 16, v196
    v_and_b32 v45, s35, v196
    v_lshlrev_b32 v46, 16, v197
    v_and_b32 v47, s35, v197
    v_lshlrev_b32 v48, 16, v198
    v_and_b32 v49, s35, v198
    v_lshlrev_b32 v50, 16, v199
    v_and_b32 v51, s35, v199
    v_pk_fma_f32 v[36:37], v[44:45], v[30:31], v[36:37] op_sel_hi:[1,0,1]
    v_pk_fma_f32 v[38:39], v[46:47], v[30:31], v[38:39] op_sel_hi:[1,0,1]
    v_pk_fma_f32 v[40:41], v[48:49], v[30:31], v[40:41] op_sel_hi:[1,0,1]
    v_pk_fma_f32 v[42:43], v[50:51], v[30:31], v[42:43] op_sel_hi:[1,0,1]
    s_waitcnt vmcnt(9)
    v_lshlrev_b32 v44, 16, v200
    v_and_b32 v45, s35, v200
    v_lshlrev_b32 v46, 16, v201
    v_and_b32 v47, s35, v201
    v_lshlrev_b32 v48, 16, v202
    v_and_b32 v49, s35, v202
    v_lshlrev_b32 v50, 16, v203
    v_and_b32 v51, s35, v203
    v_pk_fma_f32 v[36:37], v[44:45], v[30:31], v[36:37] op_sel:[0,1,0] op_sel_hi:[1,1,1]
    v_pk_fma_f32 v[38:39], v[46:47], v[30:31], v[38:39] op_sel:[0,1,0] op_sel_hi:[1,1,1]
    v_pk_fma_f32 v[40:41], v[48:49], v[30:31], v[40:41] op_sel:[0,1,0] op_sel_hi:[1,1,1]
    v_pk_fma_f32 v[42:43], v[50:51], v[30:31], v[42:43] op_sel:[0,1,0] op_sel_hi:[1,1,1]
    s_waitcnt vmcnt(8)
    v_lshlrev_b32 v44, 16, v204
    v_and_b32 v45, s35, v204
    v_lshlrev_b32 v46, 16, v205
    v_and_b32 v47, s35, v205
    v_lshlrev_b32 v48, 16, v206
    v_and_b32 v49, s35, v206
    v_lshlrev_b32 v50, 16, v207
    v_and_b32 v51, s35, v207
    v_pk_fma_f32 v[36:37], v[44:45], v[32:33], v[36:37] op_sel_hi:[1,0,1]
    v_pk_fma_f32 v[38:39], v[46:47], v[32:33], v[38:39] op_sel_hi:[1,0,1]
    v_pk_fma_f32 v[40:41], v[48:49], v[32:33], v[40:41] op_sel_hi:[1,0,1]
    v_pk_fma_f32 v[42:43], v[50:51], v[32:33], v[42:43] op_sel_hi:[1,0,1]
    s_waitcnt vmcnt(7)
    v_lshlrev_b32 v44, 16, v208
    v_and_b32 v45, s35, v208
    v_lshlrev_b32 v46, 16, v209
    v_and_b32 v47, s35, v209
    v_lshlrev_b32 v48, 16, v210
    v_and_b32 v49, s35, v210
    v_lshlrev_b32 v50, 16, v211
    v_and_b32 v51, s35, v211
    v_pk_fma_f32 v[36:37], v[44:45], v[32:33], v[36:37] op_sel:[0,1,0] op_sel_hi:[1,1,1]
    v_pk_fma_f32 v[38:39], v[46:47], v[32:33], v[38:39] op_sel:[0,1,0] op_sel_hi:[1,1,1]
    v_pk_fma_f32 v[40:41], v[48:49], v[32:33], v[40:41] op_sel:[0,1,0] op_sel_hi:[1,1,1]
    v_pk_fma_f32 v[42:43], v[50:51], v[32:33], v[42:43] op_sel:[0,1,0] op_sel_hi:[1,1,1]
    s_waitcnt vmcnt(6)
    v_lshlrev_b32 v44, 16, v212
    v_and_b32 v45, s35, v212
    v_lshlrev_b32 v46, 16, v213
    v_and_b32 v47, s35, v213
    v_lshlrev_b32 v48, 16, v214
    v_and_b32 v49, s35, v214
    v_lshlrev_b32 v50, 16, v215
    v_and_b32 v51, s35, v215
    v_pk_fma_f32 v[36:37], v[44:45], v[34:35], v[36:37] op_sel_hi:[1,0,1]
    v_pk_fma_f32 v[38:39], v[46:47], v[34:35], v[38:39] op_sel_hi:[1,0,1]
    v_pk_fma_f32 v[40:41], v[48:49], v[34:35], v[40:41] op_sel_hi:[1,0,1]
    v_pk_fma_f32 v[42:43], v[50:51], v[34:35], v[42:43] op_sel_hi:[1,0,1]
    s_waitcnt vmcnt(5)
    v_lshlrev_b32 v44, 16, v216
    v_and_b32 v45, s35, v216
    v_lshlrev_b32 v46, 16, v217
    v_and_b32 v47, s35, v217
    v_lshlrev_b32 v48, 16, v218
    v_and_b32 v49, s35, v218
    v_lshlrev_b32 v50, 16, v219
    v_and_b32 v51, s35, v219
    v_pk_fma_f32 v[36:37], v[44:45], v[34:35], v[36:37] op_sel:[0,1,0] op_sel_hi:[1,1,1]
    v_pk_fma_f32 v[38:39], v[46:47], v[34:35], v[38:39] op_sel:[0,1,0] op_sel_hi:[1,1,1]
    v_pk_fma_f32 v[40:41], v[48:49], v[34:35], v[40:41] op_sel:[0,1,0] op_sel_hi:[1,1,1]
    v_pk_fma_f32 v[42:43], v[50:51], v[34:35], v[42:43] op_sel:[0,1,0] op_sel_hi:[1,1,1]
    v_lshlrev_b32 v6, 5, v0
    v_add_u32 v6, 123904, v6
    ds_write_b128 v6, v[36:39]
    ds_write_b128 v6, v[40:43] offset:16
    s_waitcnt lgkmcnt(0)
    s_barrier
    s_cmp_lg_u32 s30, 0
    s_cbranch_scc1 L_p_57
    v_lshlrev_b32 v6, 2, v0
    v_add_u32 v7, 123904, v6
    ds_read_b32 v140, v7 offset:0
    ds_read_b32 v141, v7 offset:256
    ds_read_b32 v142, v7 offset:512
    ds_read_b32 v143, v7 offset:768
    ds_read_b32 v144, v7 offset:1024
    ds_read_b32 v145, v7 offset:1280
    ds_read_b32 v146, v7 offset:1536
    ds_read_b32 v147, v7 offset:1792
    ds_read_b32 v148, v7 offset:2048
    ds_read_b32 v149, v7 offset:2304
    ds_read_b32 v150, v7 offset:2560
    ds_read_b32 v151, v7 offset:2816
    ds_read_b32 v152, v7 offset:3072
    ds_read_b32 v153, v7 offset:3328
    ds_read_b32 v154, v7 offset:3584
    s_waitcnt lgkmcnt(0)
    ds_read_b32 v155, v7 offset:3840
    ds_read_b32 v156, v7 offset:4096
    ds_read_b32 v157, v7 offset:4352
    ds_read_b32 v158, v7 offset:4608
    ds_read_b32 v159, v7 offset:4864
    ds_read_b32 v160, v7 offset:5120
    ds_read_b32 v161, v7 offset:5376
    ds_read_b32 v162, v7 offset:5632
    ds_read_b32 v163, v7 offset:5888
    ds_read_b32 v164, v7 offset:6144
    ds_read_b32 v165, v7 offset:6400
    ds_read_b32 v166, v7 offset:6656
    ds_read_b32 v167, v7 offset:6912
    ds_read_b32 v168, v7 offset:7168
    ds_read_b32 v169, v7 offset:7424
    ds_read_b32 v170, v7 offset:7680
    ds_read_b32 v171, v7 offset:7936
    s_waitcnt lgkmcnt(0)
    v_add_f32 v140, v140, v156
    v_add_f32 v141, v141, v157
    v_add_f32 v142, v142, v158
    v_add_f32 v143, v143, v159
    v_add_f32 v144, v144, v160
    v_add_f32 v145, v145, v161
    v_add_f32 v146, v146, v162
    v_add_f32 v147, v147, v163
    v_add_f32 v148, v148, v164
    v_add_f32 v149, v149, v165
    v_add_f32 v150, v150, v166
    v_add_f32 v151, v151, v167
    v_add_f32 v152, v152, v168
    v_add_f32 v153, v153, v169
    v_add_f32 v154, v154, v170
    v_add_f32 v155, v155, v171
    v_add_f32 v140, v140, v148
    v_add_f32 v141, v141, v149
    v_add_f32 v142, v142, v150
    v_add_f32 v143, v143, v151
    v_add_f32 v144, v144, v152
    v_add_f32 v145, v145, v153
    v_add_f32 v146, v146, v154
    v_add_f32 v147, v147, v155
    v_add_f32 v140, v140, v144
    v_add_f32 v141, v141, v145
    v_add_f32 v142, v142, v146
    v_add_f32 v143, v143, v147
    v_add_f32 v140, v140, v142
    v_add_f32 v141, v141, v143
    v_add_f32 v140, v140, v141
    v_cvt_pk_bf16_f32 v140, v140, v140
    v_lshlrev_b32 v140, 16, v140
    v_add_f32 v141, 1.0, v140
    v_cvt_pk_bf16_f32 v141, v141, v141
    v_lshlrev_b32 v141, 16, v141
    s_mul_i32 s33, s62, 205
    s_lshr_b32 s33, s33, 11
    s_cmp_eq_u32 s33, 1
    s_cselect_b64 vcc, -1, 0
    s_cmp_eq_u32 s33, 4
    s_cselect_b64 vcc, -1, vcc
    v_cndmask_b32 v140, v140, v141, vcc
    s_and_b32 s34, s31, 0xffff
    s_cmp_lt_u32 s33, 5
    s_cselect_b32 s34, s34, 0
    v_or_b32 v140, s34, v140
    s_lshl_b32 s33, s62, 8
    s_add_u32 s33, s33, 0x1600000
    buffer_store_dword v140, v6, s[4:7], s33 offen sc1
L_p_57:
L_p_56:
    s_cmp_lg_u32 s30, 3
    s_cbranch_scc1 L_p_58
    s_lshl_b32 s33, s28, 10
    s_add_u32 s33, s33, 0x1780080
    v_lshl_add_u32 v2, v1, 2, s33
    s_mov_b32 exec_lo, 0xffffffff
    s_mov_b32 exec_hi, 0
    s_mov_b32 s3, 40
L_p_59:
    buffer_load_dword v3, v2, s[4:7], 0 offen sc1
    s_sub_u32 s3, s3, 1
    s_waitcnt vmcnt(0)
    v_cmp_ne_u32 vcc, s44, v3
    s_cbranch_vccz L_p_62
    s_cmp_lg_u32 s3, 0
    s_cbranch_scc1 L_p_59
    s_lshl_b32 s33, s28, 10
    s_add_u32 s33, s33, 0x1780000
    s_lshl_b32 s34, s29, 2
    s_add_u32 s33, s33, s34
    v_mov_b32 v2, s33
    v_mov_b32 v3, s44
    s_mov_b32 exec_lo, 0x1
    s_mov_b32 exec_hi, 0
    buffer_store_dword v3, v2, s[4:7], 0 offen sc1
    s_mov_b64 exec, -1
    s_lshl_b32 s33, s28, 10
    s_add_u32 s33, s33, 0x1780080
    v_lshl_add_u32 v2, v1, 2, s33
    v_lshrrev_b32 v4, 5, v1
    v_mul_u32_u24 v4, 256, v4
    v_sub_u32 v2, v2, v4
    s_mov_b32 s3, 1048576
L_p_60:
    buffer_load_dword v3, v2, s[4:7], 0 offen sc1
    s_sub_u32 s3, s3, 1
    s_cmp_eq_u32 s3, 0
    s_cbranch_scc1 L_end
    s_waitcnt vmcnt(0)
    v_cmp_ne_u32 vcc, s44, v3
    v_subrev_u32 v4, s31, v3
    v_cmp_le_u32 s[0:1], 8, v4
    s_cmp_eq_u32 vcc_lo, 0
    s_cbranch_scc1 L_p_62
    s_cmp_lg_u32 s1, 0
    s_cbranch_scc1 L_p_60
    s_cmp_eq_u32 vcc_hi, 0
    s_cbranch_scc1 L_p_60
    s_mov_b32 s32, 1
    s_add_u32 s44, s31, 8
    s_lshl_b32 s33, s28, 10
    s_add_u32 s33, s33, 0x1780080
    s_lshl_b32 s34, s29, 2
    s_add_u32 s33, s33, s34
    v_mov_b32 v2, s33
    v_mov_b32 v3, s44
    s_mov_b32 exec_lo, 0x1
    s_mov_b32 exec_hi, 0
    s_cmp_lg_u32 s32, 0
    s_cbranch_scc1 L_p_63
    buffer_store_dword v3, v2, s[4:7], 0 offen
    s_branch L_p_64
L_p_63:
    buffer_wbl2 sc1
    s_waitcnt vmcnt(0)
    buffer_store_dword v3, v2, s[4:7], 0 offen sc1
L_p_64:
    s_mov_b64 exec, -1
L_p_62:
    s_mov_b64 exec, -1
L_p_58:
    s_waitcnt vmcnt(0) lgkmcnt(0)
    s_barrier
    s_cmp_lg_u32 s30, 3
    s_cbranch_scc1 L_p_65
    s_lshl_b32 s33, s28, 10
    s_add_u32 s33, s33, 0x1780100
    s_lshl_b32 s34, s29, 2
    s_add_u32 s33, s33, s34
    v_mov_b32 v2, s33
    v_mov_b32 v3, s44
    s_mov_b32 exec_lo, 0x1
    s_mov_b32 exec_hi, 0
    s_cmp_lg_u32 s32, 0
    s_cbranch_scc1 L_p_66
    buffer_store_dword v3, v2, s[4:7], 0 offen
    s_branch L_p_67
L_p_66:
    buffer_wbl2 sc1
    s_waitcnt vmcnt(0)
    buffer_store_dword v3, v2, s[4:7], 0 offen sc1
L_p_67:
    s_mov_b64 exec, -1
L_p_65:
    s_lshl_b32 s33, s28, 5
    s_add_u32 s33, s33, s29
    s_mul_i32 s34, s30, 160
    v_and_b32 v2, 7, v1
    v_lshrrev_b32 v3, 3, v1
    v_lshl_add_u32 v4, v3, 2, s34
    s_lshl_b32 s66, s33, 3
    v_add_u32 v6, s66, v3
    v_mul_u32_u24 v6, 1280, v6
    v_lshl_add_u32 v6, v2, 3, v6
    s_lshl_b32 s66, s34, 1
    v_add_u32 v6, s66, v6
    v_lshlrev_b32 v15, 2, v4
    v_add_u32 v15, 65536, v15
    v_add_u32 v7, s34, v1
    v_lshlrev_b32 v7, 5, v7
    s_lshr_b32 s66, s33, 1
    s_and_b32 s67, s33, 1
    s_mul_i32 s68, s66, 20480
    s_lshl_b32 s33, s67, 4
    s_add_u32 s68, s68, s33
    s_add_u32 s68, s68, 0x300000
    v_add_u32 v7, s68, v7
    v_lshrrev_b32 v8, 4, v1
    v_lshlrev_b32 v8, 3, v8
    v_bfe_u32 v9, v1, 1, 1
    v_lshl_add_u32 v8, v9, 2, v8
    v_bfe_u32 v9, v1, 2, 2
    v_add_u32 v8, v8, v9
    v_lshlrev_b32 v8, 4, v8
    v_and_b32 v9, 1, v1
    v_lshl_add_u32 v8, v9, 3, v8
    s_mul_i32 s41, s30, 3072
    s_add_u32 s41, s41, 65536
    v_add_u32 v8, s41, v8
    v_lshlrev_b32 v10, 5, v2
    v_add_u32 v10, 78848, v10
    v_bfe_u32 v9, v1, 4, 1
    v_lshl_add_u32 v9, v9, 4, v10
    s_lshl_b32 s68, s30, 2
    v_add_u32 v9, s68, v9
    v_and_b32 v11, 3, v3
    v_lshlrev_b32 v11, 4, v11
    s_lshl_b32 s68, s67, 3
    v_add_u32 v11, s68, v11
    v_add_u32 v11, v11, v2
    v_lshlrev_b32 v11, 4, v11
    v_lshrrev_b32 v4, 2, v3
    v_lshl_add_u32 v11, v4, 3, v11
    s_mul_i32 s68, s66, 21
    s_mul_i32 s34, s30, 5
    s_add_u32 s68, s68, s34
    s_lshl_b32 s68, s68, 10
    s_add_u32 s68, s68, 0x600000
    v_add_u32 v11, s68, v11
L_p_3:
    s_cmp_ge_u32 s45, 27
    s_cselect_b32 s26, 0, s26
    s_mul_i32 s40, s28, 8
    s_lshr_b32 s40, s40, 3
    s_add_u32 s40, s40, 0
    s_lshl_b32 s33, s40, 13
    s_add_u32 m0, s63, s33
    s_mul_i32 s33, s40, 110592
    buffer_load_dwordx4 v12, s[24:27], s33 offen lds
    buffer_load_dwordx4 v13, s[24:27], s33 offen offset:1024 lds
    s_add_u32 s40, s40, 1
    s_cmp_lt_u32 s40, 8
    s_cselect_b32 s40, s40, 0
    s_lshl_b32 s33, s40, 13
    s_add_u32 m0, s63, s33
    s_mul_i32 s33, s40, 110592
    buffer_load_dwordx4 v12, s[24:27], s33 offen lds
    buffer_load_dwordx4 v13, s[24:27], s33 offen offset:1024 lds
    s_add_u32 s40, s40, 1
    s_cmp_lt_u32 s40, 8
    s_cselect_b32 s40, s40, 0
    s_lshl_b32 s33, s40, 13
    s_add_u32 m0, s63, s33
    s_mul_i32 s33, s40, 110592
    buffer_load_dwordx4 v12, s[24:27], s33 offen lds
    buffer_load_dwordx4 v13, s[24:27], s33 offen offset:1024 lds
    s_add_u32 s40, s40, 1
    s_cmp_lt_u32 s40, 8
    s_cselect_b32 s40, s40, 0
    s_lshl_b32 s33, s40, 13
    s_add_u32 m0, s63, s33
    s_mul_i32 s33, s40, 110592
    buffer_load_dwordx4 v12, s[24:27], s33 offen lds
    buffer_load_dwordx4 v13, s[24:27], s33 offen offset:1024 lds
    s_add_u32 s40, s40, 1
    s_cmp_lt_u32 s40, 8
    s_cselect_b32 s40, s40, 0
    s_lshl_b32 s33, s40, 13
    s_add_u32 m0, s63, s33
    s_mul_i32 s33, s40, 110592
    buffer_load_dwordx4 v12, s[24:27], s33 offen lds
    buffer_load_dwordx4 v13, s[24:27], s33 offen offset:1024 lds
    s_add_u32 s40, s40, 1
    s_cmp_lt_u32 s40, 8
    s_cselect_b32 s40, s40, 0
    s_lshl_b32 s33, s40, 13
    s_add_u32 m0, s63, s33
    s_mul_i32 s33, s40, 110592
    buffer_load_dwordx4 v12, s[24:27], s33 offen lds
    buffer_load_dwordx4 v13, s[24:27], s33 offen offset:1024 lds
    s_add_u32 s40, s40, 1
    s_cmp_lt_u32 s40, 8
    s_cselect_b32 s40, s40, 0
    s_lshl_b32 s33, s40, 13
    s_add_u32 m0, s63, s33
    s_mul_i32 s33, s40, 110592
    buffer_load_dwordx4 v12, s[24:27], s33 offen lds
    buffer_load_dwordx4 v13, s[24:27], s33 offen offset:1024 lds
    s_add_u32 s40, s40, 1
    s_cmp_lt_u32 s40, 8
    s_cselect_b32 s40, s40, 0
    s_lshl_b32 s33, s40, 13
    s_add_u32 m0, s63, s33
    s_mul_i32 s33, s40, 110592
    buffer_load_dwordx4 v12, s[24:27], s33 offen lds
    buffer_load_dwordx4 v13, s[24:27], s33 offen offset:1024 lds
    s_add_u32 s40, s40, 1
    s_cmp_lt_u32 s40, 8
    s_cselect_b32 s40, s40, 0
    s_cmp_lg_u32 s30, 3
    s_cbranch_scc1 L_p_68
    v_mov_b32 v2, 78352
    v_mov_b32 v3, s31
    v_mov_b32 v4, s44
    v_mov_b32 v5, s32
    ds_write2_b32 v2, v3, v4 offset0:0 offset1:1
    ds_write_b32 v2, v5 offset:8
    s_waitcnt lgkmcnt(0)
    v_lshlrev_b32 v2, 4, v1
    v_add_u32 v2, 0x1600000, v2
    s_mov_b32 m0, 65536
    s_movk_i32 s33, 0
    buffer_load_dwordx4 v2, s[4:7], s33 offen offset:0 sc1 lds
    buffer_load_dwordx4 v2, s[4:7], s33 offen offset:1024 sc1 lds
    buffer_load_dwordx4 v2, s[4:7], s33 offen offset:2048 sc1 lds
    buffer_load_dwordx4 v2, s[4:7], s33 offen offset:3072 sc1 lds
    s_mov_b32 m0, 69632
    s_movk_i32 s33, 4096
    buffer_load_dwordx4 v2, s[4:7], s33 offen offset:0 sc1 lds
    buffer_load_dwordx4 v2, s[4:7], s33 offen offset:1024 sc1 lds
    buffer_load_dwordx4 v2, s[4:7], s33 offen offset:2048 sc1 lds
    buffer_load_dwordx4 v2, s[4:7], s33 offen offset:3072 sc1 lds
    s_mov_b32 m0, 73728
    s_movk_i32 s33, 8192
    buffer_load_dwordx4 v2, s[4:7], s33 offen offset:0 sc1 lds
    buffer_load_dwordx4 v2, s[4:7], s33 offen offset:1024 sc1 lds
    buffer_load_dwordx4 v2, s[4:7], s33 offen offset:2048 sc1 lds
    buffer_load_dwordx4 v2, s[4:7], s33 offen offset:3072 sc1 lds
    s_mov_b32 m0, 77824
    s_movk_i32 s33, 12288
    s_mov_b32 exec_lo, 0xffffffff
    s_mov_b32 exec_hi, 0
    buffer_load_dwordx4 v2, s[4:7], s33 offen offset:0 sc1 lds
    s_mov_b64 exec, -1
L_p_68:
    s_waitcnt vmcnt(0)
L_p_2:
    s_cmp_lg_u32 s30, 0
    s_cbranch_scc1 L_p_69
    s_lshl_b32 s33, s28, 5
    s_add_u32 s33, s33, s29
    s_lshr_b32 s34, s33, 1
    s_mul_i32 s34, s34, 21504
    s_and_b32 s33, s33, 1
    s_lshl_b32 s33, s33, 7
    s_add_u32 s33, s33, s34
    s_add_u32 s33, s33, 0x600000
    v_lshl_add_u32 v2, v1, 8, s33
    v_add_u32 v3, 16384, v2
    s_mov_b32 exec_lo, -1
    s_mov_b32 exec_hi, 0xffffffff
    buffer_load_dword v250, v2, s[4:7], 0 offen sc1
    s_mov_b64 exec, -1
    s_mov_b32 exec_lo, 0xffff
    s_mov_b32 exec_hi, 0
    buffer_load_dword v251, v3, s[4:7], 0 offen sc1
    s_mov_b64 exec, -1
L_p_69:
    s_cmp_lg_u32 s30, 3
    s_cbranch_scc1 L_p_70
    s_cmp_lg_u32 s29, 31
    s_cbranch_scc1 L_p_71
    s_lshl_b32 s33, s28, 10
    s_add_u32 s33, s33, 0x1780100
    v_lshl_add_u32 v2, v1, 2, s33
    s_mov_b32 exec_lo, 0xff0fffff
    s_mov_b32 exec_hi, 0
    s_mov_b32 s3, 1048576
L_p_72:
    buffer_load_dword v3, v2, s[4:7], 0 offen sc1
    s_waitcnt vmcnt(0)
    v_cmp_ne_u32 vcc, s44, v3
    s_cbranch_vccz L_p_73
    s_sub_u32 s3, s3, 1
    s_cmp_lg_u32 s3, 0
    s_cbranch_scc1 L_p_72
    s_mov_b64 exec, -1
    s_branch L_end
L_p_73:
    s_mov_b64 exec, -1
    s_lshl_b32 s33, s28, 2
    s_add_u32 s33, s33, 0x1780180
    v_lshlrev_b32 v2, 10, v1
    v_add_u32 v2, s33, v2
    v_mov_b32 v3, s31
    s_mov_b32 exec_lo, 0xff
    s_mov_b32 exec_hi, 0
    buffer_store_dword v3, v2, s[4:7], 0 offen sc1
    s_mov_b64 exec, -1
L_p_70:
L_p_71:
    s_lshr_b32 s33, s29, 2
    s_mul_i32 s43, s30, 14
    s_cmp_eq_u32 s30, 3
    s_cselect_b32 s43, 41, s43
    s_mul_i32 s33, s33, 54
    s_add_u32 s33, s33, s43
    s_mul_i32 s33, s33, 5120
    s_add_u32 s33, s33, 0x1300000
    v_lshl_add_u32 v14, v1, 4, s33
    s_cmp_ge_u32 s30, 2
    s_cselect_b32 s42, 0x40000000, 0
    s_mul_i32 s40, s28, 7
    s_lshr_b32 s40, s40, 3
    s_add_u32 s40, s40, 10
    v_and_b32 v2, 7, v1
    v_lshrrev_b32 v3, 3, v1
    v_lshl_add_u32 v2, v2, 3, v3
    v_lshlrev_b32 v2, 2, v2
    ds_bpermute_b32 v240, v2, v240
    ds_bpermute_b32 v241, v2, v241
    ds_bpermute_b32 v242, v2, v242
    ds_bpermute_b32 v243, v2, v243
    ds_bpermute_b32 v244, v2, v244
    ds_bpermute_b32 v245, v2, v245
    s_lshl_b32 s33, s40, 13
    s_add_u32 m0, s63, s33
    s_mul_i32 s33, s40, 110592
    buffer_load_dwordx4 v12, s[24:27], s33 offen lds
    buffer_load_dwordx4 v13, s[24:27], s33 offen offset:1024 lds
    s_add_u32 s40, s40, 1
    s_cmp_lt_u32 s40, 17
    s_cselect_b32 s40, s40, 10
    ds_bpermute_b32 v246, v2, v246
    ds_bpermute_b32 v247, v2, v247
    ds_bpermute_b32 v248, v2, v248
    ds_bpermute_b32 v249, v2, v249
    s_waitcnt lgkmcnt(0)
    v_lshlrev_b32 v40, 16, v240
    v_and_b32 v41, s35, v240
    v_lshlrev_b32 v42, 16, v241
    v_and_b32 v43, s35, v241
    v_lshlrev_b32 v44, 16, v242
    v_and_b32 v45, s35, v242
    s_lshl_b32 s33, s40, 13
    s_add_u32 m0, s63, s33
    s_mul_i32 s33, s40, 110592
    buffer_load_dwordx4 v12, s[24:27], s33 offen lds
    buffer_load_dwordx4 v13, s[24:27], s33 offen offset:1024 lds
    s_add_u32 s40, s40, 1
    s_cmp_lt_u32 s40, 17
    s_cselect_b32 s40, s40, 10
    v_lshlrev_b32 v46, 16, v243
    v_and_b32 v47, s35, v243
    v_lshlrev_b32 v48, 16, v244
    v_and_b32 v49, s35, v244
    v_lshlrev_b32 v50, 16, v245
    v_and_b32 v51, s35, v245
    v_lshlrev_b32 v52, 16, v246
    v_and_b32 v53, s35, v246
    v_lshlrev_b32 v54, 16, v247
    v_and_b32 v55, s35, v247
    s_lshl_b32 s33, s40, 13
    s_add_u32 m0, s63, s33
    s_mul_i32 s33, s40, 110592
    buffer_load_dwordx4 v12, s[24:27], s33 offen lds
    buffer_load_dwordx4 v13, s[24:27], s33 offen offset:1024 lds
    s_add_u32 s40, s40, 1
    s_cmp_lt_u32 s40, 17
    s_cselect_b32 s40, s40, 10
    v_lshlrev_b32 v56, 16, v248
    v_and_b32 v57, s35, v248
    v_lshlrev_b32 v58, 16, v249
    v_and_b32 v59, s35, v249
    v_pk_add_f32 v[200:201], v[40:41], v[42:43]
    v_pk_mul_f32 v[202:203], v[40:41], v[40:41]
    v_pk_fma_f32 v[202:203], v[42:43], v[42:43], v[202:203]
    v_pk_add_f32 v[200:201], v[200:201], v[44:45]
    v_pk_fma_f32 v[202:203], v[44:45], v[44:45], v[202:203]
    v_pk_add_f32 v[200:201], v[200:201], v[46:47]
    s_lshl_b32 s33, s40, 13
    s_add_u32 m0, s63, s33
    s_mul_i32 s33, s40, 110592
    buffer_load_dwordx4 v12, s[24:27], s33 offen lds
    buffer_load_dwordx4 v13, s[24:27], s33 offen offset:1024 lds
    s_add_u32 s40, s40, 1
    s_cmp_lt_u32 s40, 17
    s_cselect_b32 s40, s40, 10
    v_pk_fma_f32 v[202:203], v[46:47], v[46:47], v[202:203]
    v_pk_add_f32 v[200:201], v[200:201], v[48:49]
    v_pk_fma_f32 v[202:203], v[48:49], v[48:49], v[202:203]
    v_pk_add_f32 v[200:201], v[200:201], v[50:51]
    v_pk_fma_f32 v[202:203], v[50:51], v[50:51], v[202:203]
    v_pk_add_f32 v[200:201], v[200:201], v[52:53]
    v_pk_fma_f32 v[202:203], v[52:53], v[52:53], v[202:203]
    v_pk_add_f32 v[200:201], v[200:201], v[54:55]
    v_pk_fma_f32 v[202:203], v[54:55], v[54:55], v[202:203]
    v_pk_add_f32 v[200:201], v[200:201], v[56:57]
    s_lshl_b32 s33, s40, 13
    s_add_u32 m0, s63, s33
    s_mul_i32 s33, s40, 110592
    buffer_load_dwordx4 v12, s[24:27], s33 offen lds
    buffer_load_dwordx4 v13, s[24:27], s33 offen offset:1024 lds
    s_add_u32 s40, s40, 1
    s_cmp_lt_u32 s40, 17
    s_cselect_b32 s40, s40, 10
    v_pk_fma_f32 v[202:203], v[56:57], v[56:57], v[202:203]
    v_pk_add_f32 v[200:201], v[200:201], v[58:59]
    v_pk_fma_f32 v[202:203], v[58:59], v[58:59], v[202:203]
    v_add_f32 v200, v200, v201
    v_add_f32 v202, v202, v203
    s_nop 0
    v_add_f32 v200, v200, v200 row_ror:8 row_mask:0xf bank_mask:0xf
    v_add_f32 v202, v202, v202 row_ror:8 row_mask:0xf bank_mask:0xf
    s_nop 1
    v_permlane16_swap_b32 v200, v202
    v_add_f32 v200, v200, v202
    v_mov_b32 v202, v200
    s_lshl_b32 s33, s40, 13
    s_add_u32 m0, s63, s33
    s_mul_i32 s33, s40, 110592
    buffer_load_dwordx4 v12, s[24:27], s33 offen lds
    buffer_load_dwordx4 v13, s[24:27], s33 offen offset:1024 lds
    s_add_u32 s40, s40, 1
    s_cmp_lt_u32 s40, 17
    s_cselect_b32 s40, s40, 10
    v_permlane32_swap_b32 v200, v202
    v_add_f32 v200, v200, v202
    ds_write_b32 v9, v200 offset:0
    s_barrier
    v_lshlrev_b32 v2, 4, v0
    v_add_u32 v2, 65536, v2
    v_add_u32 v3, 12288, v2
    v_cmp_gt_u32 vcc, 32, v0
    s_nop 1
    v_cndmask_b32 v3, v2, v3, vcc
    v_mov_b32 v4, 78336
    ds_read_b128 v[100:103], v2 offset:0
    ds_read_b128 v[104:107], v2 offset:4096
    ds_read_b128 v[108:111], v2 offset:8192
    ds_read_b128 v[112:115], v3
    ds_read_b128 v[140:143], v4 offset:16
    s_waitcnt lgkmcnt(0)
    v_readfirstlane_b32 s44, v141
    v_readfirstlane_b32 s32, v142
    v_xor_b32 v120, v140, v100
    v_xor_b32 v121, v140, v101
    v_xor_b32 v122, v140, v102
    v_xor_b32 v123, v140, v103
    v_xor_b32 v124, v140, v104
    v_xor_b32 v125, v140, v105
    v_xor_b32 v126, v140, v106
    v_xor_b32 v127, v140, v107
    v_xor_b32 v128, v140, v108
    v_xor_b32 v129, v140, v109
    v_xor_b32 v130, v140, v110
    v_xor_b32 v131, v140, v111
    v_xor_b32 v132, v140, v112
    v_xor_b32 v133, v140, v113
    v_xor_b32 v134, v140, v114
    v_xor_b32 v135, v140, v115
    v_and_b32 v100, s35, v100
    v_and_b32 v101, s35, v101
    v_and_b32 v102, s35, v102
    v_and_b32 v103, s35, v103
    v_and_b32 v104, s35, v104
    v_and_b32 v105, s35, v105
    v_and_b32 v106, s35, v106
    v_and_b32 v107, s35, v107
    v_and_b32 v108, s35, v108
    v_and_b32 v109, s35, v109
    v_and_b32 v110, s35, v110
    v_and_b32 v111, s35, v111
    v_and_b32 v112, s35, v112
    v_and_b32 v113, s35, v113
    v_and_b32 v114, s35, v114
    v_and_b32 v115, s35, v115
    v_or3_b32 v120, v120, v121, v122
    v_or3_b32 v120, v120, v123, v124
    v_or3_b32 v120, v120, v125, v126
    v_or3_b32 v120, v120, v127, v128
    v_or3_b32 v120, v120, v129, v130
    v_or3_b32 v120, v120, v131, v132
    v_or3_b32 v120, v120, v133, v134
    v_or3_b32 v120, v120, v135, v135
    v_and_b32 v120, 0xffff, v120
    v_cmp_ne_u32 vcc, 0, v120
    s_nop 0
    s_cmp_lg_u64 vcc, 0
    s_cselect_b32 s33, 1, 0
    s_lshl_b32 s34, s30, 2
    v_add_u32 v4, s34, v4
    v_mov_b32 v5, s33
    ds_write_b32 v4, v5
    s_cmp_eq_u32 s33, 1
    s_cbranch_scc1 L_p_74
    ds_write_b128 v2, v[100:103] offset:0
    ds_write_b128 v2, v[104:107] offset:4096
    ds_write_b128 v2, v[108:111] offset:8192
    ds_write_b128 v3, v[112:115]
L_p_74:
    s_waitcnt lgkmcnt(0)
    s_barrier
    s_mov_b32 s69, 1048576
L_p_75:
    v_mov_b32 v4, 78336
    ds_read_b128 v[100:103], v4
    s_waitcnt lgkmcnt(0)
    v_or3_b32 v100, v100, v101, v102
    v_or_b32 v100, v100, v103
    s_nop 0
    v_readfirstlane_b32 s33, v100
    s_nop 0
    s_cmp_eq_u32 s33, 0
    s_cbranch_scc1 L_p_76
    s_sub_u32 s69, s69, 1
    s_cmp_eq_u32 s69, 0
    s_cbranch_scc1 L_end
    s_barrier
    s_cmp_lg_u32 s30, 3
    s_cbranch_scc1 L_p_77
    v_mov_b32 v2, 78352
    v_mov_b32 v3, s31
    v_mov_b32 v4, s44
    v_mov_b32 v5, s32
    ds_write2_b32 v2, v3, v4 offset0:0 offset1:1
    ds_write_b32 v2, v5 offset:8
    s_waitcnt lgkmcnt(0)
    v_lshlrev_b32 v2, 4, v1
    v_add_u32 v2, 0x1600000, v2
    s_mov_b32 m0, 65536
    s_movk_i32 s33, 0
    buffer_load_dwordx4 v2, s[4:7], s33 offen offset:0 sc1 lds
    buffer_load_dwordx4 v2, s[4:7], s33 offen offset:1024 sc1 lds
    buffer_load_dwordx4 v2, s[4:7], s33 offen offset:2048 sc1 lds
    buffer_load_dwordx4 v2, s[4:7], s33 offen offset:3072 sc1 lds
    s_mov_b32 m0, 69632
    s_movk_i32 s33, 4096
    buffer_load_dwordx4 v2, s[4:7], s33 offen offset:0 sc1 lds
    buffer_load_dwordx4 v2, s[4:7], s33 offen offset:1024 sc1 lds
    buffer_load_dwordx4 v2, s[4:7], s33 offen offset:2048 sc1 lds
    buffer_load_dwordx4 v2, s[4:7], s33 offen offset:3072 sc1 lds
    s_mov_b32 m0, 73728
    s_movk_i32 s33, 8192
    buffer_load_dwordx4 v2, s[4:7], s33 offen offset:0 sc1 lds
    buffer_load_dwordx4 v2, s[4:7], s33 offen offset:1024 sc1 lds
    buffer_load_dwordx4 v2, s[4:7], s33 offen offset:2048 sc1 lds
    buffer_load_dwordx4 v2, s[4:7], s33 offen offset:3072 sc1 lds
    s_mov_b32 m0, 77824
    s_movk_i32 s33, 12288
    s_mov_b32 exec_lo, 0xffffffff
    s_mov_b32 exec_hi, 0
    buffer_load_dwordx4 v2, s[4:7], s33 offen offset:0 sc1 lds
    s_mov_b64 exec, -1
    s_waitcnt vmcnt(0)
L_p_77:
    s_barrier
    v_lshlrev_b32 v2, 4, v0
    v_add_u32 v2, 65536, v2
    v_add_u32 v3, 12288, v2
    v_cmp_gt_u32 vcc, 32, v0
    s_nop 1
    v_cndmask_b32 v3, v2, v3, vcc
    v_mov_b32 v4, 78336
    ds_read_b128 v[100:103], v2 offset:0
    ds_read_b128 v[104:107], v2 offset:4096
    ds_read_b128 v[108:111], v2 offset:8192
    ds_read_b128 v[112:115], v3
    ds_read_b128 v[140:143], v4 offset:16
    s_waitcnt lgkmcnt(0)
    v_readfirstlane_b32 s44, v141
    v_readfirstlane_b32 s32, v142
    v_xor_b32 v120, v140, v100
    v_xor_b32 v121, v140, v101
    v_xor_b32 v122, v140, v102
    v_xor_b32 v123, v140, v103
    v_xor_b32 v124, v140, v104
    v_xor_b32 v125, v140, v105
    v_xor_b32 v126, v140, v106
    v_xor_b32 v127, v140, v107
    v_xor_b32 v128, v140, v108
    v_xor_b32 v129, v140, v109
    v_xor_b32 v130, v140, v110
    v_xor_b32 v131, v140, v111
    v_xor_b32 v132, v140, v112
    v_xor_b32 v133, v140, v113
    v_xor_b32 v134, v140, v114
    v_xor_b32 v135, v140, v115
    v_and_b32 v100, s35, v100
    v_and_b32 v101, s35, v101
    v_and_b32 v102, s35, v102
    v_and_b32 v103, s35, v103
    v_and_b32 v104, s35, v104
    v_and_b32 v105, s35, v105
    v_and_b32 v106, s35, v106
    v_and_b32 v107, s35, v107
    v_and_b32 v108, s35, v108
    v_and_b32 v109, s35, v109
    v_and_b32 v110, s35, v110
    v_and_b32 v111, s35, v111
    v_and_b32 v112, s35, v112
    v_and_b32 v113, s35, v113
    v_and_b32 v114, s35, v114
    v_and_b32 v115, s35, v115
    v_or3_b32 v120, v120, v121, v122
    v_or3_b32 v120, v120, v123, v124
    v_or3_b32 v120, v120, v125, v126
    v_or3_b32 v120, v120, v127, v128
    v_or3_b32 v120, v120, v129, v130
    v_or3_b32 v120, v120, v131, v132
    v_or3_b32 v120, v120, v133, v134
    v_or3_b32 v120, v120, v135, v135
    v_and_b32 v120, 0xffff, v120
    v_cmp_ne_u32 vcc, 0, v120
    s_nop 0
    s_cmp_lg_u64 vcc, 0
    s_cselect_b32 s33, 1, 0
    s_lshl_b32 s34, s30, 2
    v_add_u32 v4, s34, v4
    v_mov_b32 v5, s33
    ds_write_b32 v4, v5
    s_cmp_eq_u32 s33, 1
    s_cbranch_scc1 L_p_78
    ds_write_b128 v2, v[100:103] offset:0
    ds_write_b128 v2, v[104:107] offset:4096
    ds_write_b128 v2, v[108:111] offset:8192
    ds_write_b128 v3, v[112:115]
L_p_78:
    s_waitcnt lgkmcnt(0)
    s_barrier
    s_branch L_p_75
L_p_76:
    ds_read_b128 v[200:203], v10 offset:0
    ds_read_b128 v[204:207], v10 offset:16
    s_waitcnt lgkmcnt(0)
    v_pk_add_f32 v[200:201], v[200:201], v[202:203]
    v_pk_add_f32 v[204:205], v[204:205], v[206:207]
    v_add_f32 v200, v200, v201
    v_add_f32 v204, v204, v205
    v_mul_f32 v200, 0x3acccccd, v200
    s_lshl_b32 s33, s40, 13
    s_add_u32 m0, s63, s33
    s_mul_i32 s33, s40, 110592
    buffer_load_dwordx4 v12, s[24:27], s33 offen lds
    buffer_load_dwordx4 v13, s[24:27], s33 offen offset:1024 lds
    s_add_u32 s40, s40, 1
    s_cmp_lt_u32 s40, 17
    s_cselect_b32 s40, s40, 10
    v_mul_f32 v204, 0x3acccccd, v204
    v_fma_f32 v204, -v200, v200, v204
    v_max_f32 v204, 0, v204
    v_add_f32 v204, 0x3727c5ac, v204
    v_rsq_f32 v202, v204
    s_nop 0
    v_mul_f32 v203, -v200, v202
    ds_read_b128 v[120:123], v15 offset:2560
    ds_read_b128 v[124:127], v15 offset:2688
    ds_read_b128 v[128:131], v15 offset:2816
    ds_read_b128 v[132:135], v15 offset:2944
    ds_read_b128 v[136:139], v15 offset:3072
    ds_read_b128 v[100:103], v15 offset:0
    ds_read_b128 v[104:107], v15 offset:128
    ds_read_b128 v[108:111], v15 offset:256
    ds_read_b128 v[112:115], v15 offset:384
    ds_read_b128 v[116:119], v15 offset:512
    v_pk_fma_f32 v[60:61], v[40:41], v[202:203], v[202:203] op_sel:[0,0,1] op_sel_hi:[1,0,1]
    v_pk_fma_f32 v[62:63], v[42:43], v[202:203], v[202:203] op_sel:[0,0,1] op_sel_hi:[1,0,1]
    v_pk_fma_f32 v[64:65], v[44:45], v[202:203], v[202:203] op_sel:[0,0,1] op_sel_hi:[1,0,1]
    v_pk_fma_f32 v[66:67], v[46:47], v[202:203], v[202:203] op_sel:[0,0,1] op_sel_hi:[1,0,1]
    v_pk_fma_f32 v[68:69], v[48:49], v[202:203], v[202:203] op_sel:[0,0,1] op_sel_hi:[1,0,1]
    v_pk_fma_f32 v[70:71], v[50:51], v[202:203], v[202:203] op_sel:[0,0,1] op_sel_hi:[1,0,1]
    v_pk_fma_f32 v[72:73], v[52:53], v[202:203], v[202:203] op_sel:[0,0,1] op_sel_hi:[1,0,1]
    v_pk_fma_f32 v[74:75], v[54:55], v[202:203], v[202:203] op_sel:[0,0,1] op_sel_hi:[1,0,1]
    v_pk_fma_f32 v[76:77], v[56:57], v[202:203], v[202:203] op_sel:[0,0,1] op_sel_hi:[1,0,1]
    v_pk_fma_f32 v[78:79], v[58:59], v[202:203], v[202:203] op_sel:[0,0,1] op_sel_hi:[1,0,1]
    ds_read_b128 v[140:143], v15 offset:5120
    ds_read_b128 v[144:147], v15 offset:5248
    ds_read_b128 v[148:151], v15 offset:5376
    ds_read_b128 v[152:155], v15 offset:5504
    ds_read_b128 v[156:159], v15 offset:5632
    s_waitcnt lgkmcnt(5)
    v_pk_fma_f32 v[60:61], v[60:61], v[120:121], v[100:101]
    v_pk_fma_f32 v[62:63], v[62:63], v[122:123], v[102:103]
    v_pk_fma_f32 v[64:65], v[64:65], v[124:125], v[104:105]
    v_pk_fma_f32 v[66:67], v[66:67], v[126:127], v[106:107]
    v_pk_fma_f32 v[68:69], v[68:69], v[128:129], v[108:109]
    v_pk_fma_f32 v[70:71], v[70:71], v[130:131], v[110:111]
    v_pk_fma_f32 v[72:73], v[72:73], v[132:133], v[112:113]
    v_pk_fma_f32 v[74:75], v[74:75], v[134:135], v[114:115]
    v_pk_fma_f32 v[76:77], v[76:77], v[136:137], v[116:117]
    v_pk_fma_f32 v[78:79], v[78:79], v[138:139], v[118:119]
    ds_read_b128 v[160:163], v15 offset:7680
    ds_read_b128 v[164:167], v15 offset:7808
    ds_read_b128 v[168:171], v15 offset:7936
    ds_read_b128 v[172:175], v15 offset:8064
    ds_read_b128 v[176:179], v15 offset:8192
    ds_read_b128 v[180:183], v15 offset:10240
    ds_read_b128 v[184:187], v15 offset:10368
    ds_read_b128 v[188:191], v15 offset:10496
    ds_read_b128 v[192:195], v15 offset:10624
    ds_read_b128 v[196:199], v15 offset:10752
    s_waitcnt lgkmcnt(10)
    v_pk_mul_f32 v[60:61], v[60:61], v[140:141]
    v_pk_mul_f32 v[62:63], v[62:63], v[142:143]
    v_pk_mul_f32 v[64:65], v[64:65], v[144:145]
    v_pk_mul_f32 v[66:67], v[66:67], v[146:147]
    v_pk_mul_f32 v[68:69], v[68:69], v[148:149]
    v_pk_mul_f32 v[70:71], v[70:71], v[150:151]
    v_pk_mul_f32 v[72:73], v[72:73], v[152:153]
    v_pk_mul_f32 v[74:75], v[74:75], v[154:155]
    v_pk_mul_f32 v[76:77], v[76:77], v[156:157]
    v_pk_mul_f32 v[78:79], v[78:79], v[158:159]
    s_waitcnt lgkmcnt(0)
    s_cmp_lg_u32 s30, 3
    s_cbranch_scc1 L_p_79
    s_lshl_b32 s33, s28, 10
    s_add_u32 s33, s33, 0x1780180
    v_lshl_add_u32 v2, v1, 2, s33
    s_mov_b32 exec_lo, 0xff
    s_mov_b32 exec_hi, 0
    s_mov_b32 s3, 1048576
L_p_80:
    buffer_load_dword v3, v2, s[4:7], 0 offen sc1
    s_waitcnt vmcnt(0)
    v_cmp_ne_u32 vcc, s31, v3
    s_cbranch_vccz L_p_81
    s_sub_u32 s3, s3, 1
    s_cmp_lg_u32 s3, 0
    s_cbranch_scc1 L_p_80
    s_mov_b64 exec, -1
    s_branch L_end
L_p_81:
    s_mov_b64 exec, -1
    s_cmp_lg_u32 s2, 0
    s_cbranch_scc1 L_p_82
    v_mov_b32 v2, 0x1782200
    v_mov_b32 v3, s31
    s_mov_b32 exec_lo, 0x1
    s_mov_b32 exec_hi, 0
    buffer_store_dword v3, v2, s[4:7], 0 offen sc1
    s_mov_b64 exec, -1
L_p_82:
L_p_79:
    s_barrier
    s_add_u32 m0, s41, 0
    s_movk_i32 s33, 0
    buffer_load_dwordx4 v7, s[4:7], s33 offen sc1 lds
    s_add_u32 m0, s41, 1024
    s_movk_i32 s33, 2048
    buffer_load_dwordx4 v7, s[4:7], s33 offen sc1 lds
    s_add_u32 m0, s41, 2048
    s_movk_i32 s33, 4096
    buffer_load_dwordx4 v7, s[4:7], s33 offen sc1 lds
    s_mul_i32 s40, s28, 3
    s_lshr_b32 s40, s40, 3
    s_add_u32 s40, s40, 17
    s_lshl_b32 s33, s40, 13
    s_add_u32 m0, s63, s33
    s_mul_i32 s33, s40, 110592
    buffer_load_dwordx4 v12, s[24:27], s33 offen lds
    buffer_load_dwordx4 v13, s[24:27], s33 offen offset:1024 lds
    s_add_u32 s40, s40, 1
    s_cmp_lt_u32 s40, 20
    s_cselect_b32 s40, s40, 17
    s_lshl_b32 s33, s40, 13
    s_add_u32 m0, s63, s33
    s_mul_i32 s33, s40, 110592
    buffer_load_dwordx4 v12, s[24:27], s33 offen lds
    buffer_load_dwordx4 v13, s[24:27], s33 offen offset:1024 lds
    s_add_u32 s40, s40, 1
    s_cmp_lt_u32 s40, 20
    s_cselect_b32 s40, s40, 17
    s_lshl_b32 s33, s40, 13
    s_add_u32 m0, s63, s33
    s_mul_i32 s33, s40, 110592
    buffer_load_dwordx4 v12, s[24:27], s33 offen lds
    buffer_load_dwordx4 v13, s[24:27], s33 offen offset:1024 lds
    s_add_u32 s40, s40, 1
    s_cmp_lt_u32 s40, 20
    s_cselect_b32 s40, s40, 17
    s_waitcnt vmcnt(6)
    ds_read_b64_tr_b16 v[208:209], v8 offset:0
    ds_read_b64_tr_b16 v[210:211], v8 offset:512
    ds_read_b64_tr_b16 v[212:213], v8 offset:1024
    ds_read_b64_tr_b16 v[214:215], v8 offset:1536
    ds_read_b64_tr_b16 v[216:217], v8 offset:2048
    s_waitcnt lgkmcnt(4)
    v_lshlrev_b32 v80, 16, v208
    v_and_b32 v81, s35, v208
    v_lshlrev_b32 v82, 16, v209
    v_and_b32 v83, s35, v209
    s_waitcnt lgkmcnt(3)
    v_lshlrev_b32 v84, 16, v210
    v_and_b32 v85, s35, v210
    v_lshlrev_b32 v86, 16, v211
    v_and_b32 v87, s35, v211
    s_waitcnt lgkmcnt(2)
    v_lshlrev_b32 v88, 16, v212
    v_and_b32 v89, s35, v212
    v_lshlrev_b32 v90, 16, v213
    v_and_b32 v91, s35, v213
    s_waitcnt lgkmcnt(1)
    v_lshlrev_b32 v92, 16, v214
    v_and_b32 v93, s35, v214
    v_lshlrev_b32 v94, 16, v215
    v_and_b32 v95, s35, v215
    s_waitcnt lgkmcnt(0)
    v_lshlrev_b32 v96, 16, v216
    v_and_b32 v97, s35, v216
    v_lshlrev_b32 v98, 16, v217
    v_and_b32 v99, s35, v217
    v_pk_fma_f32 v[40:41], v[60:61], v[80:81], v[40:41]
    v_pk_fma_f32 v[42:43], v[62:63], v[82:83], v[42:43]
    v_pk_fma_f32 v[44:45], v[64:65], v[84:85], v[44:45]
    v_pk_fma_f32 v[46:47], v[66:67], v[86:87], v[46:47]
    v_pk_fma_f32 v[48:49], v[68:69], v[88:89], v[48:49]
    v_pk_fma_f32 v[50:51], v[70:71], v[90:91], v[50:51]
    v_pk_fma_f32 v[52:53], v[72:73], v[92:93], v[52:53]
    v_pk_fma_f32 v[54:55], v[74:75], v[94:95], v[54:55]
    v_pk_fma_f32 v[56:57], v[76:77], v[96:97], v[56:57]
    v_pk_fma_f32 v[58:59], v[78:79], v[98:99], v[58:59]
    v_pk_add_f32 v[200:201], v[40:41], v[42:43]
    v_pk_mul_f32 v[202:203], v[40:41], v[40:41]
    v_pk_fma_f32 v[202:203], v[42:43], v[42:43], v[202:203]
    v_pk_add_f32 v[200:201], v[200:201], v[44:45]
    v_pk_fma_f32 v[202:203], v[44:45], v[44:45], v[202:203]
    v_pk_add_f32 v[200:201], v[200:201], v[46:47]
    v_pk_fma_f32 v[202:203], v[46:47], v[46:47], v[202:203]
    v_pk_add_f32 v[200:201], v[200:201], v[48:49]
    v_pk_fma_f32 v[202:203], v[48:49], v[48:49], v[202:203]
    v_pk_add_f32 v[200:201], v[200:201], v[50:51]
    v_pk_fma_f32 v[202:203], v[50:51], v[50:51], v[202:203]
    v_pk_add_f32 v[200:201], v[200:201], v[52:53]
    v_pk_fma_f32 v[202:203], v[52:53], v[52:53], v[202:203]
    v_pk_add_f32 v[200:201], v[200:201], v[54:55]
    v_pk_fma_f32 v[202:203], v[54:55], v[54:55], v[202:203]
    v_pk_add_f32 v[200:201], v[200:201], v[56:57]
    v_pk_fma_f32 v[202:203], v[56:57], v[56:57], v[202:203]
    v_pk_add_f32 v[200:201], v[200:201], v[58:59]
    v_pk_fma_f32 v[202:203], v[58:59], v[58:59], v[202:203]
    v_add_f32 v200, v200, v201
    v_add_f32 v202, v202, v203
    s_nop 0
    v_add_f32 v200, v200, v200 row_ror:8 row_mask:0xf bank_mask:0xf
    v_add_f32 v202, v202, v202 row_ror:8 row_mask:0xf bank_mask:0xf
    s_nop 1
    v_permlane16_swap_b32 v200, v202
    v_add_f32 v200, v200, v202
    v_mov_b32 v202, v200
    s_nop 1
    v_permlane32_swap_b32 v200, v202
    v_add_f32 v200, v200, v202
    ds_write_b32 v9, v200 offset:256
    s_waitcnt lgkmcnt(0)
    s_barrier
    ds_read_b128 v[200:203], v10 offset:256
    ds_read_b128 v[204:207], v10 offset:272
    s_waitcnt lgkmcnt(0)
    v_pk_add_f32 v[200:201], v[200:201], v[202:203]
    v_pk_add_f32 v[204:205], v[204:205], v[206:207]
    v_add_f32 v200, v200, v201
    v_add_f32 v204, v204, v205
    v_mul_f32 v200, 0x3acccccd, v200
    v_mul_f32 v204, 0x3acccccd, v204
    v_fma_f32 v204, -v200, v200, v204
    v_max_f32 v204, 0, v204
    v_add_f32 v204, 0x3727c5ac, v204
    v_rsq_f32 v202, v204
    s_nop 0
    v_mul_f32 v203, -v200, v202
    v_pk_fma_f32 v[60:61], v[40:41], v[202:203], v[202:203] op_sel:[0,0,1] op_sel_hi:[1,0,1]
    v_pk_fma_f32 v[62:63], v[42:43], v[202:203], v[202:203] op_sel:[0,0,1] op_sel_hi:[1,0,1]
    v_pk_fma_f32 v[64:65], v[44:45], v[202:203], v[202:203] op_sel:[0,0,1] op_sel_hi:[1,0,1]
    v_pk_fma_f32 v[66:67], v[46:47], v[202:203], v[202:203] op_sel:[0,0,1] op_sel_hi:[1,0,1]
    v_pk_fma_f32 v[68:69], v[48:49], v[202:203], v[202:203] op_sel:[0,0,1] op_sel_hi:[1,0,1]
    v_pk_fma_f32 v[70:71], v[50:51], v[202:203], v[202:203] op_sel:[0,0,1] op_sel_hi:[1,0,1]
    v_pk_fma_f32 v[72:73], v[52:53], v[202:203], v[202:203] op_sel:[0,0,1] op_sel_hi:[1,0,1]
    v_pk_fma_f32 v[74:75], v[54:55], v[202:203], v[202:203] op_sel:[0,0,1] op_sel_hi:[1,0,1]
    v_pk_fma_f32 v[76:77], v[56:57], v[202:203], v[202:203] op_sel:[0,0,1] op_sel_hi:[1,0,1]
    v_pk_fma_f32 v[78:79], v[58:59], v[202:203], v[202:203] op_sel:[0,0,1] op_sel_hi:[1,0,1]
    v_pk_fma_f32 v[60:61], v[60:61], v[180:181], v[160:161]
    v_pk_fma_f32 v[62:63], v[62:63], v[182:183], v[162:163]
    v_pk_fma_f32 v[64:65], v[64:65], v[184:185], v[164:165]
    v_pk_fma_f32 v[66:67], v[66:67], v[186:187], v[166:167]
    v_pk_fma_f32 v[68:69], v[68:69], v[188:189], v[168:169]
    v_pk_fma_f32 v[70:71], v[70:71], v[190:191], v[170:171]
    v_pk_fma_f32 v[72:73], v[72:73], v[192:193], v[172:173]
    v_pk_fma_f32 v[74:75], v[74:75], v[194:195], v[174:175]
    v_pk_fma_f32 v[76:77], v[76:77], v[196:197], v[176:177]
    v_pk_fma_f32 v[78:79], v[78:79], v[198:199], v[178:179]
    v_cvt_pk_bf16_f32 v80, v60, v61
    v_cvt_pk_bf16_f32 v81, v62, v63
    s_movk_i32 s33, 0
    buffer_store_dwordx2 v[80:81], v11, s[4:7], s33 offen
    v_cvt_pk_bf16_f32 v82, v64, v65
    v_cvt_pk_bf16_f32 v83, v66, v67
    s_movk_i32 s33, 1024
    buffer_store_dwordx2 v[82:83], v11, s[4:7], s33 offen
    v_cvt_pk_bf16_f32 v84, v68, v69
    v_cvt_pk_bf16_f32 v85, v70, v71
    s_movk_i32 s33, 2048
    buffer_store_dwordx2 v[84:85], v11, s[4:7], s33 offen
    v_cvt_pk_bf16_f32 v86, v72, v73
    v_cvt_pk_bf16_f32 v87, v74, v75
    s_movk_i32 s33, 3072
    buffer_store_dwordx2 v[86:87], v11, s[4:7], s33 offen
    v_cvt_pk_bf16_f32 v88, v76, v77
    v_cvt_pk_bf16_f32 v89, v78, v79
    s_movk_i32 s33, 4096
    buffer_store_dwordx2 v[88:89], v11, s[4:7], s33 offen
    v_cvt_pk_bf16_f32 v16, v40, v41
    v_cvt_pk_bf16_f32 v17, v42, v43
    v_cvt_pk_bf16_f32 v18, v44, v45
    v_cvt_pk_bf16_f32 v19, v46, v47
    v_cvt_pk_bf16_f32 v20, v48, v49
    v_cvt_pk_bf16_f32 v21, v50, v51
    v_cvt_pk_bf16_f32 v22, v52, v53
    v_cvt_pk_bf16_f32 v23, v54, v55
    v_cvt_pk_bf16_f32 v24, v56, v57
    v_cvt_pk_bf16_f32 v25, v58, v59
    s_lshl_b32 s33, s28, 5
    s_add_u32 s33, s33, s29
    s_lshr_b32 s34, s33, 1
    s_mul_i32 s34, s34, 160
    s_mul_i32 s66, s30, 40
    s_add_u32 s34, s34, s66
    s_lshl_b32 s34, s34, 7
    s_and_b32 s33, s33, 1
    s_lshl_b32 s33, s33, 6
    s_add_u32 s33, s33, s34
    v_and_b32 v15, 7, v1
    v_lshrrev_b32 v2, 3, v1
    v_lshlrev_b32 v15, 3, v15
    v_lshl_add_u32 v15, v2, 7, v15
    v_add_u32 v15, s33, v15
    s_waitcnt vmcnt(0) lgkmcnt(0)
    s_barrier
    s_cmp_lg_u32 s30, 3
    s_cbranch_scc1 L_p_83
    s_lshl_b32 s33, s28, 10
    s_add_u32 s33, s33, 0x1780200
    s_lshl_b32 s34, s29, 2
    s_add_u32 s33, s33, s34
    v_mov_b32 v2, s33
    v_mov_b32 v3, s44
    s_mov_b32 exec_lo, 0x1
    s_mov_b32 exec_hi, 0
    s_cmp_lg_u32 s32, 0
    s_cbranch_scc1 L_p_84
    buffer_store_dword v3, v2, s[4:7], 0 offen
    s_branch L_p_85
L_p_84:
    buffer_wbl2 sc1
    s_waitcnt vmcnt(0)
    buffer_store_dword v3, v2, s[4:7], 0 offen sc1
L_p_85:
    s_mov_b64 exec, -1
L_p_83:
    s_cmp_ge_u32 s45, 27
    s_cbranch_scc1 L_p_87
    v_lshrrev_b32 v2, 2, v1
    v_lshlrev_b32 v2, 7, v2
    v_and_b32 v3, 3, v1
    v_lshl_add_u32 v2, v3, 3, v2
    v_bfe_u32 v3, v1, 3, 2
    v_lshl_add_u32 v6, v3, 5, v2
    v_xor_b32 v4, 1, v3
    v_lshl_add_u32 v7, v4, 5, v2
    v_xor_b32 v4, 2, v3
    v_lshl_add_u32 v8, v4, 5, v2
    v_xor_b32 v4, 3, v3
    v_lshl_add_u32 v9, v4, 5, v2
    s_lshl_b32 s33, s28, 4
    s_lshl_b32 s34, s30, 2
    s_add_u32 s33, s33, s34
    s_mul_i32 s34, s33, 21504
    s_add_u32 s34, s34, 0x600000
    v_lshl_add_u32 v10, v1, 4, s34
    s_mul_i32 s33, s33, 55
    s_lshl_b32 s34, s45, 1
    s_add_u32 s33, s33, s34
    s_lshl_b32 s33, s33, 10
    s_add_u32 s33, s33, 0xc00000
    v_lshl_add_u32 v11, v1, 4, s33
    ds_read_b64_tr_b16 v[40:41], v6 offset:0
    ds_read_b64_tr_b16 v[42:43], v6 offset:2048
    ds_read_b64_tr_b16 v[44:45], v6 offset:4096
    ds_read_b64_tr_b16 v[46:47], v6 offset:6144
    ds_read_b64_tr_b16 v[48:49], v7 offset:0
    ds_read_b64_tr_b16 v[50:51], v7 offset:2048
    s_cmp_lg_u32 s30, 3
    s_cbranch_scc1 L_p_88
    s_lshl_b32 s33, s28, 7
    s_add_u32 s33, s33, 0x1783f80
    v_lshl_add_u32 v4, v1, 2, s33
    s_lshl_b32 s33, s28, 10
    s_add_u32 s33, s33, 0x1780200
    v_lshl_add_u32 v2, v1, 2, s33
    v_cmp_gt_u32 vcc, 32, v1
    v_mov_b32 v5, s31
    s_nop 0
    v_cndmask_b32 v2, v4, v2, vcc
    v_mov_b32 v4, s44
    v_cndmask_b32 v4, v5, v4, vcc
    s_mov_b32 exec_lo, -1
    s_mov_b32 exec_hi, 0xffffffff
    s_mov_b32 s3, 1048576
L_p_89:
    buffer_load_dword v3, v2, s[4:7], 0 offen sc1
    s_waitcnt vmcnt(0)
    v_cmp_ne_u32 vcc, v4, v3
    s_cbranch_vccz L_p_90
    s_sub_u32 s3, s3, 1
    s_cmp_lg_u32 s3, 0
    s_cbranch_scc1 L_p_89
    s_mov_b64 exec, -1
    s_branch L_end
L_p_90:
    s_mov_b64 exec, -1
L_p_88:
    s_barrier
    s_mov_b32 s33, 0
    buffer_load_dwordx4 v[60:63], v10, s[4:7], s33 offen sc1
    s_mov_b32 s33, 21504
    buffer_load_dwordx4 v[64:67], v10, s[4:7], s33 offen sc1
    s_mov_b32 s33, 43008
    buffer_load_dwordx4 v[68:71], v10, s[4:7], s33 offen sc1
    s_mov_b32 s33, 64512
    buffer_load_dwordx4 v[72:75], v10, s[4:7], s33 offen sc1
    s_mov_b32 s33, 1024
    buffer_load_dwordx4 v[76:79], v10, s[4:7], s33 offen sc1
    s_mov_b32 s33, 22528
    buffer_load_dwordx4 v[80:83], v10, s[4:7], s33 offen sc1
    s_mov_b32 s33, 44032
    buffer_load_dwordx4 v[84:87], v10, s[4:7], s33 offen sc1
    s_mov_b32 s33, 65536
    buffer_load_dwordx4 v[88:91], v10, s[4:7], s33 offen sc1
    s_waitcnt lgkmcnt(4)
    s_waitcnt vmcnt(4)
    v_mfma_f32_16x16x32_bf16 v[124:127], v[40:43], v[60:63], 0
    ds_read_b64_tr_b16 v[52:53], v7 offset:4096
    v_mfma_f32_16x16x32_bf16 v[156:159], v[40:43], v[64:67], 0
    s_mov_b32 s33, 2048
    buffer_load_dwordx4 v[92:95], v10, s[4:7], s33 offen sc1
    v_mfma_f32_16x16x32_bf16 v[188:191], v[40:43], v[68:71], 0
    ds_read_b64_tr_b16 v[54:55], v7 offset:6144
    v_mfma_f32_16x16x32_bf16 v[220:223], v[40:43], v[72:75], 0
    s_waitcnt lgkmcnt(4)
    v_mfma_f32_16x16x32_bf16 v[140:143], v[44:47], v[60:63], 0
    ds_read_b64_tr_b16 v[56:57], v8 offset:0
    v_mfma_f32_16x16x32_bf16 v[172:175], v[44:47], v[64:67], 0
    s_mov_b32 s33, 23552
    buffer_load_dwordx4 v[96:99], v10, s[4:7], s33 offen sc1
    v_mfma_f32_16x16x32_bf16 v[204:207], v[44:47], v[68:71], 0
    ds_read_b64_tr_b16 v[58:59], v8 offset:2048
    v_mfma_f32_16x16x32_bf16 v[236:239], v[44:47], v[72:75], 0
    s_waitcnt lgkmcnt(4)
    v_mfma_f32_16x16x32_bf16 v[128:131], v[48:51], v[60:63], 0
    ds_read_b64_tr_b16 v[252:253], v8 offset:4096
    v_mfma_f32_16x16x32_bf16 v[160:163], v[48:51], v[64:67], 0
    s_mov_b32 s33, 45056
    buffer_load_dwordx4 v[100:103], v10, s[4:7], s33 offen sc1
    v_mfma_f32_16x16x32_bf16 v[192:195], v[48:51], v[68:71], 0
    ds_read_b64_tr_b16 v[254:255], v8 offset:6144
    v_mfma_f32_16x16x32_bf16 v[224:227], v[48:51], v[72:75], 0
    s_waitcnt lgkmcnt(4)
    v_mfma_f32_16x16x32_bf16 v[144:147], v[52:55], v[60:63], 0
    ds_read_b64_tr_b16 v[40:41], v9 offset:0
    v_mfma_f32_16x16x32_bf16 v[176:179], v[52:55], v[64:67], 0
    s_mov_b32 s33, 66560
    buffer_load_dwordx4 v[104:107], v10, s[4:7], s33 offen sc1
    v_mfma_f32_16x16x32_bf16 v[208:211], v[52:55], v[68:71], 0
    ds_read_b64_tr_b16 v[42:43], v9 offset:2048
    v_mfma_f32_16x16x32_bf16 v[240:243], v[52:55], v[72:75], 0
    s_waitcnt lgkmcnt(4)
    v_mfma_f32_16x16x32_bf16 v[132:135], v[56:59], v[60:63], 0
    ds_read_b64_tr_b16 v[44:45], v9 offset:4096
    v_mfma_f32_16x16x32_bf16 v[164:167], v[56:59], v[64:67], 0
    s_mov_b32 s33, 3072
    buffer_load_dwordx4 v[108:111], v10, s[4:7], s33 offen sc1
    v_mfma_f32_16x16x32_bf16 v[196:199], v[56:59], v[68:71], 0
    ds_read_b64_tr_b16 v[46:47], v9 offset:6144
    v_mfma_f32_16x16x32_bf16 v[228:231], v[56:59], v[72:75], 0
    s_waitcnt lgkmcnt(4)
    v_mfma_f32_16x16x32_bf16 v[148:151], v[252:255], v[60:63], 0
    ds_read_b64_tr_b16 v[48:49], v6 offset:8192
    v_mfma_f32_16x16x32_bf16 v[180:183], v[252:255], v[64:67], 0
    s_mov_b32 s33, 24576
    buffer_load_dwordx4 v[112:115], v10, s[4:7], s33 offen sc1
    v_mfma_f32_16x16x32_bf16 v[212:215], v[252:255], v[68:71], 0
    ds_read_b64_tr_b16 v[50:51], v6 offset:10240
    v_mfma_f32_16x16x32_bf16 v[244:247], v[252:255], v[72:75], 0
    s_waitcnt lgkmcnt(4)
    v_mfma_f32_16x16x32_bf16 v[136:139], v[40:43], v[60:63], 0
    ds_read_b64_tr_b16 v[52:53], v6 offset:12288
    v_mfma_f32_16x16x32_bf16 v[168:171], v[40:43], v[64:67], 0
    s_mov_b32 s33, 46080
    buffer_load_dwordx4 v[116:119], v10, s[4:7], s33 offen sc1
    v_mfma_f32_16x16x32_bf16 v[200:203], v[40:43], v[68:71], 0
    ds_read_b64_tr_b16 v[54:55], v6 offset:14336
    v_mfma_f32_16x16x32_bf16 v[232:235], v[40:43], v[72:75], 0
    s_waitcnt lgkmcnt(4)
    v_mfma_f32_16x16x32_bf16 v[152:155], v[44:47], v[60:63], 0
    ds_read_b64_tr_b16 v[56:57], v7 offset:8192
    v_mfma_f32_16x16x32_bf16 v[184:187], v[44:47], v[64:67], 0
    s_mov_b32 s33, 67584
    buffer_load_dwordx4 v[120:123], v10, s[4:7], s33 offen sc1
    v_mfma_f32_16x16x32_bf16 v[216:219], v[44:47], v[68:71], 0
    ds_read_b64_tr_b16 v[58:59], v7 offset:10240
    v_mfma_f32_16x16x32_bf16 v[248:251], v[44:47], v[72:75], 0
    s_waitcnt lgkmcnt(4)
    s_waitcnt vmcnt(8)
    v_mfma_f32_16x16x32_bf16 v[124:127], v[48:51], v[76:79], v[124:127]
    ds_read_b64_tr_b16 v[252:253], v7 offset:12288
    v_mfma_f32_16x16x32_bf16 v[156:159], v[48:51], v[80:83], v[156:159]
    s_mov_b32 s33, 4096
    buffer_load_dwordx4 v[60:63], v10, s[4:7], s33 offen sc1
    v_mfma_f32_16x16x32_bf16 v[188:191], v[48:51], v[84:87], v[188:191]
    ds_read_b64_tr_b16 v[254:255], v7 offset:14336
    v_mfma_f32_16x16x32_bf16 v[220:223], v[48:51], v[88:91], v[220:223]
    s_waitcnt lgkmcnt(4)
    v_mfma_f32_16x16x32_bf16 v[140:143], v[52:55], v[76:79], v[140:143]
    ds_read_b64_tr_b16 v[40:41], v8 offset:8192
    v_mfma_f32_16x16x32_bf16 v[172:175], v[52:55], v[80:83], v[172:175]
    s_mov_b32 s33, 25600
    buffer_load_dwordx4 v[64:67], v10, s[4:7], s33 offen sc1
    v_mfma_f32_16x16x32_bf16 v[204:207], v[52:55], v[84:87], v[204:207]
    ds_read_b64_tr_b16 v[42:43], v8 offset:10240
    v_mfma_f32_16x16x32_bf16 v[236:239], v[52:55], v[88:91], v[236:239]
    s_waitcnt lgkmcnt(4)
    v_mfma_f32_16x16x32_bf16 v[128:131], v[56:59], v[76:79], v[128:131]
    ds_read_b64_tr_b16 v[44:45], v8 offset:12288
    v_mfma_f32_16x16x32_bf16 v[160:163], v[56:59], v[80:83], v[160:163]
    s_mov_b32 s33, 47104
    buffer_load_dwordx4 v[68:71], v10, s[4:7], s33 offen sc1
    v_mfma_f32_16x16x32_bf16 v[192:195], v[56:59], v[84:87], v[192:195]
    ds_read_b64_tr_b16 v[46:47], v8 offset:14336
    v_mfma_f32_16x16x32_bf16 v[224:227], v[56:59], v[88:91], v[224:227]
    s_waitcnt lgkmcnt(4)
    v_mfma_f32_16x16x32_bf16 v[144:147], v[252:255], v[76:79], v[144:147]
    ds_read_b64_tr_b16 v[48:49], v9 offset:8192
    v_mfma_f32_16x16x32_bf16 v[176:179], v[252:255], v[80:83], v[176:179]
    s_mov_b32 s33, 68608
    buffer_load_dwordx4 v[72:75], v10, s[4:7], s33 offen sc1
    v_mfma_f32_16x16x32_bf16 v[208:211], v[252:255], v[84:87], v[208:211]
    ds_read_b64_tr_b16 v[50:51], v9 offset:10240
    v_mfma_f32_16x16x32_bf16 v[240:243], v[252:255], v[88:91], v[240:243]
    s_waitcnt lgkmcnt(4)
    v_mfma_f32_16x16x32_bf16 v[132:135], v[40:43], v[76:79], v[132:135]
    ds_read_b64_tr_b16 v[52:53], v9 offset:12288
    v_mfma_f32_16x16x32_bf16 v[164:167], v[40:43], v[80:83], v[164:167]
    s_mov_b32 s34, 0x900000
    buffer_store_dwordx2 v[16:17], v15, s[4:7], s34 offen offset:0
    v_mfma_f32_16x16x32_bf16 v[196:199], v[40:43], v[84:87], v[196:199]
    ds_read_b64_tr_b16 v[54:55], v9 offset:14336
    v_mfma_f32_16x16x32_bf16 v[228:231], v[40:43], v[88:91], v[228:231]
    s_waitcnt lgkmcnt(4)
    v_mfma_f32_16x16x32_bf16 v[148:151], v[44:47], v[76:79], v[148:151]
    ds_read_b64_tr_b16 v[56:57], v6 offset:16384
    v_mfma_f32_16x16x32_bf16 v[180:183], v[44:47], v[80:83], v[180:183]
    s_mov_b32 s34, 0x900000
    buffer_store_dwordx2 v[18:19], v15, s[4:7], s34 offen offset:1024
    v_mfma_f32_16x16x32_bf16 v[212:215], v[44:47], v[84:87], v[212:215]
    ds_read_b64_tr_b16 v[58:59], v6 offset:18432
    v_mfma_f32_16x16x32_bf16 v[244:247], v[44:47], v[88:91], v[244:247]
    s_waitcnt lgkmcnt(4)
    v_mfma_f32_16x16x32_bf16 v[136:139], v[48:51], v[76:79], v[136:139]
    ds_read_b64_tr_b16 v[252:253], v6 offset:20480
    v_mfma_f32_16x16x32_bf16 v[168:171], v[48:51], v[80:83], v[168:171]
    s_mov_b32 s34, 0x900000
    buffer_store_dwordx2 v[20:21], v15, s[4:7], s34 offen offset:2048
    v_mfma_f32_16x16x32_bf16 v[200:203], v[48:51], v[84:87], v[200:203]
    ds_read_b64_tr_b16 v[254:255], v6 offset:22528
    v_mfma_f32_16x16x32_bf16 v[232:235], v[48:51], v[88:91], v[232:235]
    s_waitcnt lgkmcnt(4)
    v_mfma_f32_16x16x32_bf16 v[152:155], v[52:55], v[76:79], v[152:155]
    ds_read_b64_tr_b16 v[40:41], v7 offset:16384
    v_mfma_f32_16x16x32_bf16 v[184:187], v[52:55], v[80:83], v[184:187]
    s_mov_b32 s34, 0x900000
    buffer_store_dwordx2 v[22:23], v15, s[4:7], s34 offen offset:3072
    v_mfma_f32_16x16x32_bf16 v[216:219], v[52:55], v[84:87], v[216:219]
    ds_read_b64_tr_b16 v[42:43], v7 offset:18432
    v_mfma_f32_16x16x32_bf16 v[248:251], v[52:55], v[88:91], v[248:251]
    s_waitcnt lgkmcnt(4)
    s_waitcnt vmcnt(12)
    v_mfma_f32_16x16x32_bf16 v[124:127], v[56:59], v[92:95], v[124:127]
    ds_read_b64_tr_b16 v[44:45], v7 offset:20480
    v_mfma_f32_16x16x32_bf16 v[156:159], v[56:59], v[96:99], v[156:159]
    s_mov_b32 s33, 5120
    buffer_load_dwordx4 v[76:79], v10, s[4:7], s33 offen sc1
    v_mfma_f32_16x16x32_bf16 v[188:191], v[56:59], v[100:103], v[188:191]
    ds_read_b64_tr_b16 v[46:47], v7 offset:22528
    v_mfma_f32_16x16x32_bf16 v[220:223], v[56:59], v[104:107], v[220:223]
    s_waitcnt lgkmcnt(4)
    v_mfma_f32_16x16x32_bf16 v[140:143], v[252:255], v[92:95], v[140:143]
    ds_read_b64_tr_b16 v[48:49], v8 offset:16384
    v_mfma_f32_16x16x32_bf16 v[172:175], v[252:255], v[96:99], v[172:175]
    s_mov_b32 s33, 26624
    buffer_load_dwordx4 v[80:83], v10, s[4:7], s33 offen sc1
    v_mfma_f32_16x16x32_bf16 v[204:207], v[252:255], v[100:103], v[204:207]
    ds_read_b64_tr_b16 v[50:51], v8 offset:18432
    v_mfma_f32_16x16x32_bf16 v[236:239], v[252:255], v[104:107], v[236:239]
    s_waitcnt lgkmcnt(4)
    v_mfma_f32_16x16x32_bf16 v[128:131], v[40:43], v[92:95], v[128:131]
    ds_read_b64_tr_b16 v[52:53], v8 offset:20480
    v_mfma_f32_16x16x32_bf16 v[160:163], v[40:43], v[96:99], v[160:163]
    s_mov_b32 s33, 48128
    buffer_load_dwordx4 v[84:87], v10, s[4:7], s33 offen sc1
    v_mfma_f32_16x16x32_bf16 v[192:195], v[40:43], v[100:103], v[192:195]
    ds_read_b64_tr_b16 v[54:55], v8 offset:22528
    v_mfma_f32_16x16x32_bf16 v[224:227], v[40:43], v[104:107], v[224:227]
    s_waitcnt lgkmcnt(4)
    v_mfma_f32_16x16x32_bf16 v[144:147], v[44:47], v[92:95], v[144:147]
    ds_read_b64_tr_b16 v[56:57], v9 offset:16384
    v_mfma_f32_16x16x32_bf16 v[176:179], v[44:47], v[96:99], v[176:179]
    s_mov_b32 s33, 69632
    buffer_load_dwordx4 v[88:91], v10, s[4:7], s33 offen sc1
    v_mfma_f32_16x16x32_bf16 v[208:211], v[44:47], v[100:103], v[208:211]
    ds_read_b64_tr_b16 v[58:59], v9 offset:18432
    v_mfma_f32_16x16x32_bf16 v[240:243], v[44:47], v[104:107], v[240:243]
    s_waitcnt lgkmcnt(4)
    v_mfma_f32_16x16x32_bf16 v[132:135], v[48:51], v[92:95], v[132:135]
    ds_read_b64_tr_b16 v[252:253], v9 offset:20480
    v_mfma_f32_16x16x32_bf16 v[164:167], v[48:51], v[96:99], v[164:167]
    s_mov_b32 s34, 0x901000
    buffer_store_dwordx2 v[24:25], v15, s[4:7], s34 offen offset:0
    v_mfma_f32_16x16x32_bf16 v[196:199], v[48:51], v[100:103], v[196:199]
    ds_read_b64_tr_b16 v[254:255], v9 offset:22528
    v_mfma_f32_16x16x32_bf16 v[228:231], v[48:51], v[104:107], v[228:231]
    s_waitcnt lgkmcnt(4)
    v_mfma_f32_16x16x32_bf16 v[148:151], v[52:55], v[92:95], v[148:151]
    ds_read_b64_tr_b16 v[40:41], v6 offset:24576
    v_mfma_f32_16x16x32_bf16 v[180:183], v[52:55], v[96:99], v[180:183]
    s_mov_b32 s33, 0
    buffer_load_dwordx4 a[0:3], v14, s[4:7], s33 offen offset:0 sc1
    v_mfma_f32_16x16x32_bf16 v[212:215], v[52:55], v[100:103], v[212:215]
    ds_read_b64_tr_b16 v[42:43], v6 offset:26624
    v_mfma_f32_16x16x32_bf16 v[244:247], v[52:55], v[104:107], v[244:247]
    s_waitcnt lgkmcnt(4)
    v_mfma_f32_16x16x32_bf16 v[136:139], v[56:59], v[92:95], v[136:139]
    ds_read_b64_tr_b16 v[44:45], v6 offset:28672
    v_mfma_f32_16x16x32_bf16 v[168:171], v[56:59], v[96:99], v[168:171]
    s_mov_b32 s33, 0
    buffer_load_dwordx4 a[4:7], v14, s[4:7], s33 offen offset:1024 sc1
    v_mfma_f32_16x16x32_bf16 v[200:203], v[56:59], v[100:103], v[200:203]
    ds_read_b64_tr_b16 v[46:47], v6 offset:30720
    v_mfma_f32_16x16x32_bf16 v[232:235], v[56:59], v[104:107], v[232:235]
    s_waitcnt lgkmcnt(4)
    v_mfma_f32_16x16x32_bf16 v[152:155], v[252:255], v[92:95], v[152:155]
    ds_read_b64_tr_b16 v[48:49], v7 offset:24576
    v_mfma_f32_16x16x32_bf16 v[184:187], v[252:255], v[96:99], v[184:187]
    s_mov_b32 s33, 0
    buffer_load_dwordx4 a[8:11], v14, s[4:7], s33 offen offset:2048 sc1
    v_mfma_f32_16x16x32_bf16 v[216:219], v[252:255], v[100:103], v[216:219]
    ds_read_b64_tr_b16 v[50:51], v7 offset:26624
    v_mfma_f32_16x16x32_bf16 v[248:251], v[252:255], v[104:107], v[248:251]
    s_waitcnt lgkmcnt(4)
    s_waitcnt vmcnt(16)
    v_mfma_f32_16x16x32_bf16 v[124:127], v[40:43], v[108:111], v[124:127]
    ds_read_b64_tr_b16 v[52:53], v7 offset:28672
    v_mfma_f32_16x16x32_bf16 v[156:159], v[40:43], v[112:115], v[156:159]
    s_mov_b32 s33, 6144
    buffer_load_dwordx4 v[92:95], v10, s[4:7], s33 offen sc1
    v_mfma_f32_16x16x32_bf16 v[188:191], v[40:43], v[116:119], v[188:191]
    ds_read_b64_tr_b16 v[54:55], v7 offset:30720
    v_mfma_f32_16x16x32_bf16 v[220:223], v[40:43], v[120:123], v[220:223]
    s_waitcnt lgkmcnt(4)
    v_mfma_f32_16x16x32_bf16 v[140:143], v[44:47], v[108:111], v[140:143]
    ds_read_b64_tr_b16 v[56:57], v8 offset:24576
    v_mfma_f32_16x16x32_bf16 v[172:175], v[44:47], v[112:115], v[172:175]
    s_mov_b32 s33, 27648
    buffer_load_dwordx4 v[96:99], v10, s[4:7], s33 offen sc1
    v_mfma_f32_16x16x32_bf16 v[204:207], v[44:47], v[116:119], v[204:207]
    ds_read_b64_tr_b16 v[58:59], v8 offset:26624
    v_mfma_f32_16x16x32_bf16 v[236:239], v[44:47], v[120:123], v[236:239]
    s_waitcnt lgkmcnt(4)
    v_mfma_f32_16x16x32_bf16 v[128:131], v[48:51], v[108:111], v[128:131]
    ds_read_b64_tr_b16 v[252:253], v8 offset:28672
    v_mfma_f32_16x16x32_bf16 v[160:163], v[48:51], v[112:115], v[160:163]
    s_mov_b32 s33, 49152
    buffer_load_dwordx4 v[100:103], v10, s[4:7], s33 offen sc1
    v_mfma_f32_16x16x32_bf16 v[192:195], v[48:51], v[116:119], v[192:195]
    ds_read_b64_tr_b16 v[254:255], v8 offset:30720
    v_mfma_f32_16x16x32_bf16 v[224:227], v[48:51], v[120:123], v[224:227]
    s_waitcnt lgkmcnt(4)
    v_mfma_f32_16x16x32_bf16 v[144:147], v[52:55], v[108:111], v[144:147]
    ds_read_b64_tr_b16 v[40:41], v9 offset:24576
    v_mfma_f32_16x16x32_bf16 v[176:179], v[52:55], v[112:115], v[176:179]
    s_mov_b32 s33, 70656
    buffer_load_dwordx4 v[104:107], v10, s[4:7], s33 offen sc1
    v_mfma_f32_16x16x32_bf16 v[208:211], v[52:55], v[116:119], v[208:211]
    ds_read_b64_tr_b16 v[42:43], v9 offset:26624
    v_mfma_f32_16x16x32_bf16 v[240:243], v[52:55], v[120:123], v[240:243]
    s_waitcnt lgkmcnt(4)
    v_mfma_f32_16x16x32_bf16 v[132:135], v[56:59], v[108:111], v[132:135]
    ds_read_b64_tr_b16 v[44:45], v9 offset:28672
    v_mfma_f32_16x16x32_bf16 v[164:167], v[56:59], v[112:115], v[164:167]
    s_add_u32 m0, s63, 65536
    s_mov_b32 s33, 884736
    buffer_load_dwordx4 v12, s[24:27], s33 offen lds
    buffer_load_dwordx4 v13, s[24:27], s33 offen offset:1024 lds
    v_mfma_f32_16x16x32_bf16 v[196:199], v[56:59], v[116:119], v[196:199]
    ds_read_b64_tr_b16 v[46:47], v9 offset:30720
    v_mfma_f32_16x16x32_bf16 v[228:231], v[56:59], v[120:123], v[228:231]
    s_waitcnt lgkmcnt(4)
    v_mfma_f32_16x16x32_bf16 v[148:151], v[252:255], v[108:111], v[148:151]
    ds_read_b64_tr_b16 v[48:49], v6 offset:32768
    v_mfma_f32_16x16x32_bf16 v[180:183], v[252:255], v[112:115], v[180:183]
    v_mfma_f32_16x16x32_bf16 v[212:215], v[252:255], v[116:119], v[212:215]
    ds_read_b64_tr_b16 v[50:51], v6 offset:34816
    v_mfma_f32_16x16x32_bf16 v[244:247], v[252:255], v[120:123], v[244:247]
    s_waitcnt lgkmcnt(4)
    v_mfma_f32_16x16x32_bf16 v[136:139], v[40:43], v[108:111], v[136:139]
    ds_read_b64_tr_b16 v[52:53], v6 offset:36864
    v_mfma_f32_16x16x32_bf16 v[168:171], v[40:43], v[112:115], v[168:171]
    s_mov_b32 s33, 0
    buffer_load_dwordx4 a[12:15], v14, s[4:7], s33 offen offset:3072 sc1
    v_mfma_f32_16x16x32_bf16 v[200:203], v[40:43], v[116:119], v[200:203]
    ds_read_b64_tr_b16 v[54:55], v6 offset:38912
    v_mfma_f32_16x16x32_bf16 v[232:235], v[40:43], v[120:123], v[232:235]
    s_waitcnt lgkmcnt(4)
    v_mfma_f32_16x16x32_bf16 v[152:155], v[44:47], v[108:111], v[152:155]
    ds_read_b64_tr_b16 v[56:57], v7 offset:32768
    v_mfma_f32_16x16x32_bf16 v[184:187], v[44:47], v[112:115], v[184:187]
    s_mov_b32 s33, 4096
    buffer_load_dwordx4 a[16:19], v14, s[4:7], s33 offen offset:0 sc1
    v_mfma_f32_16x16x32_bf16 v[216:219], v[44:47], v[116:119], v[216:219]
    ds_read_b64_tr_b16 v[58:59], v7 offset:34816
    v_mfma_f32_16x16x32_bf16 v[248:251], v[44:47], v[120:123], v[248:251]
    s_waitcnt lgkmcnt(4)
    s_waitcnt vmcnt(20)
    v_mfma_f32_16x16x32_bf16 v[124:127], v[48:51], v[60:63], v[124:127]
    ds_read_b64_tr_b16 v[252:253], v7 offset:36864
    v_mfma_f32_16x16x32_bf16 v[156:159], v[48:51], v[64:67], v[156:159]
    s_mov_b32 s33, 7168
    buffer_load_dwordx4 v[108:111], v10, s[4:7], s33 offen sc1
    v_mfma_f32_16x16x32_bf16 v[188:191], v[48:51], v[68:71], v[188:191]
    ds_read_b64_tr_b16 v[254:255], v7 offset:38912
    v_mfma_f32_16x16x32_bf16 v[220:223], v[48:51], v[72:75], v[220:223]
    s_waitcnt lgkmcnt(4)
    v_mfma_f32_16x16x32_bf16 v[140:143], v[52:55], v[60:63], v[140:143]
    ds_read_b64_tr_b16 v[40:41], v8 offset:32768
    v_mfma_f32_16x16x32_bf16 v[172:175], v[52:55], v[64:67], v[172:175]
    s_mov_b32 s33, 28672
    buffer_load_dwordx4 v[112:115], v10, s[4:7], s33 offen sc1
    v_mfma_f32_16x16x32_bf16 v[204:207], v[52:55], v[68:71], v[204:207]
    ds_read_b64_tr_b16 v[42:43], v8 offset:34816
    v_mfma_f32_16x16x32_bf16 v[236:239], v[52:55], v[72:75], v[236:239]
    s_waitcnt lgkmcnt(4)
    v_mfma_f32_16x16x32_bf16 v[128:131], v[56:59], v[60:63], v[128:131]
    ds_read_b64_tr_b16 v[44:45], v8 offset:36864
    v_mfma_f32_16x16x32_bf16 v[160:163], v[56:59], v[64:67], v[160:163]
    s_mov_b32 s33, 50176
    buffer_load_dwordx4 v[116:119], v10, s[4:7], s33 offen sc1
    v_mfma_f32_16x16x32_bf16 v[192:195], v[56:59], v[68:71], v[192:195]
    ds_read_b64_tr_b16 v[46:47], v8 offset:38912
    v_mfma_f32_16x16x32_bf16 v[224:227], v[56:59], v[72:75], v[224:227]
    s_waitcnt lgkmcnt(4)
    v_mfma_f32_16x16x32_bf16 v[144:147], v[252:255], v[60:63], v[144:147]
    ds_read_b64_tr_b16 v[48:49], v9 offset:32768
    v_mfma_f32_16x16x32_bf16 v[176:179], v[252:255], v[64:67], v[176:179]
    s_mov_b32 s33, 71680
    buffer_load_dwordx4 v[120:123], v10, s[4:7], s33 offen sc1
    v_mfma_f32_16x16x32_bf16 v[208:211], v[252:255], v[68:71], v[208:211]
    ds_read_b64_tr_b16 v[50:51], v9 offset:34816
    v_mfma_f32_16x16x32_bf16 v[240:243], v[252:255], v[72:75], v[240:243]
    s_waitcnt lgkmcnt(4)
    v_mfma_f32_16x16x32_bf16 v[132:135], v[40:43], v[60:63], v[132:135]
    ds_read_b64_tr_b16 v[52:53], v9 offset:36864
    v_mfma_f32_16x16x32_bf16 v[164:167], v[40:43], v[64:67], v[164:167]
    s_mov_b32 s33, 4096
    buffer_load_dwordx4 a[20:23], v14, s[4:7], s33 offen offset:1024 sc1
    v_mfma_f32_16x16x32_bf16 v[196:199], v[40:43], v[68:71], v[196:199]
    ds_read_b64_tr_b16 v[54:55], v9 offset:38912
    v_mfma_f32_16x16x32_bf16 v[228:231], v[40:43], v[72:75], v[228:231]
    s_waitcnt lgkmcnt(4)
    v_mfma_f32_16x16x32_bf16 v[148:151], v[44:47], v[60:63], v[148:151]
    ds_read_b64_tr_b16 v[56:57], v6 offset:40960
    v_mfma_f32_16x16x32_bf16 v[180:183], v[44:47], v[64:67], v[180:183]
    s_mov_b32 s33, 4096
    buffer_load_dwordx4 a[24:27], v14, s[4:7], s33 offen offset:2048 sc1
    v_mfma_f32_16x16x32_bf16 v[212:215], v[44:47], v[68:71], v[212:215]
    ds_read_b64_tr_b16 v[58:59], v6 offset:43008
    v_mfma_f32_16x16x32_bf16 v[244:247], v[44:47], v[72:75], v[244:247]
    s_waitcnt lgkmcnt(4)
    v_mfma_f32_16x16x32_bf16 v[136:139], v[48:51], v[60:63], v[136:139]
    ds_read_b64_tr_b16 v[252:253], v6 offset:45056
    v_mfma_f32_16x16x32_bf16 v[168:171], v[48:51], v[64:67], v[168:171]
    s_mov_b32 s33, 4096
    buffer_load_dwordx4 a[28:31], v14, s[4:7], s33 offen offset:3072 sc1
    v_mfma_f32_16x16x32_bf16 v[200:203], v[48:51], v[68:71], v[200:203]
    ds_read_b64_tr_b16 v[254:255], v6 offset:47104
    v_mfma_f32_16x16x32_bf16 v[232:235], v[48:51], v[72:75], v[232:235]
    s_waitcnt lgkmcnt(4)
    v_mfma_f32_16x16x32_bf16 v[152:155], v[52:55], v[60:63], v[152:155]
    ds_read_b64_tr_b16 v[40:41], v7 offset:40960
    v_mfma_f32_16x16x32_bf16 v[184:187], v[52:55], v[64:67], v[184:187]
    v_mfma_f32_16x16x32_bf16 v[216:219], v[52:55], v[68:71], v[216:219]
    ds_read_b64_tr_b16 v[42:43], v7 offset:43008
    v_mfma_f32_16x16x32_bf16 v[248:251], v[52:55], v[72:75], v[248:251]
    s_waitcnt lgkmcnt(4)
    s_waitcnt vmcnt(19)
    v_mfma_f32_16x16x32_bf16 v[124:127], v[56:59], v[76:79], v[124:127]
    ds_read_b64_tr_b16 v[44:45], v7 offset:45056
    v_mfma_f32_16x16x32_bf16 v[156:159], v[56:59], v[80:83], v[156:159]
    s_mov_b32 s33, 10240
    buffer_load_dwordx4 v[60:63], v10, s[4:7], s33 offen sc1
    v_mfma_f32_16x16x32_bf16 v[188:191], v[56:59], v[84:87], v[188:191]
    ds_read_b64_tr_b16 v[46:47], v7 offset:47104
    v_mfma_f32_16x16x32_bf16 v[220:223], v[56:59], v[88:91], v[220:223]
    s_waitcnt lgkmcnt(4)
    v_mfma_f32_16x16x32_bf16 v[140:143], v[252:255], v[76:79], v[140:143]
    ds_read_b64_tr_b16 v[48:49], v8 offset:40960
    v_mfma_f32_16x16x32_bf16 v[172:175], v[252:255], v[80:83], v[172:175]
    s_mov_b32 s33, 31744
    buffer_load_dwordx4 v[64:67], v10, s[4:7], s33 offen sc1
    v_mfma_f32_16x16x32_bf16 v[204:207], v[252:255], v[84:87], v[204:207]
    ds_read_b64_tr_b16 v[50:51], v8 offset:43008
    v_mfma_f32_16x16x32_bf16 v[236:239], v[252:255], v[88:91], v[236:239]
    s_waitcnt lgkmcnt(4)
    v_mfma_f32_16x16x32_bf16 v[128:131], v[40:43], v[76:79], v[128:131]
    ds_read_b64_tr_b16 v[52:53], v8 offset:45056
    v_mfma_f32_16x16x32_bf16 v[160:163], v[40:43], v[80:83], v[160:163]
    s_mov_b32 s33, 53248
    buffer_load_dwordx4 v[68:71], v10, s[4:7], s33 offen sc1
    v_mfma_f32_16x16x32_bf16 v[192:195], v[40:43], v[84:87], v[192:195]
    ds_read_b64_tr_b16 v[54:55], v8 offset:47104
    v_mfma_f32_16x16x32_bf16 v[224:227], v[40:43], v[88:91], v[224:227]
    s_waitcnt lgkmcnt(4)
    v_mfma_f32_16x16x32_bf16 v[144:147], v[44:47], v[76:79], v[144:147]
    ds_read_b64_tr_b16 v[56:57], v9 offset:40960
    v_mfma_f32_16x16x32_bf16 v[176:179], v[44:47], v[80:83], v[176:179]
    s_mov_b32 s33, 74752
    buffer_load_dwordx4 v[72:75], v10, s[4:7], s33 offen sc1
    v_mfma_f32_16x16x32_bf16 v[208:211], v[44:47], v[84:87], v[208:211]
    ds_read_b64_tr_b16 v[58:59], v9 offset:43008
    v_mfma_f32_16x16x32_bf16 v[240:243], v[44:47], v[88:91], v[240:243]
    s_waitcnt lgkmcnt(4)
    v_mfma_f32_16x16x32_bf16 v[132:135], v[48:51], v[76:79], v[132:135]
    ds_read_b64_tr_b16 v[252:253], v9 offset:45056
    v_mfma_f32_16x16x32_bf16 v[164:167], v[48:51], v[80:83], v[164:167]
    s_mov_b32 s33, 8192
    buffer_load_dwordx4 a[32:35], v14, s[4:7], s33 offen offset:0 sc1
    v_mfma_f32_16x16x32_bf16 v[196:199], v[48:51], v[84:87], v[196:199]
    ds_read_b64_tr_b16 v[254:255], v9 offset:47104
    v_mfma_f32_16x16x32_bf16 v[228:231], v[48:51], v[88:91], v[228:231]
    s_waitcnt lgkmcnt(4)
    v_mfma_f32_16x16x32_bf16 v[148:151], v[52:55], v[76:79], v[148:151]
    ds_read_b64_tr_b16 v[40:41], v6 offset:49152
    v_mfma_f32_16x16x32_bf16 v[180:183], v[52:55], v[80:83], v[180:183]
    s_mov_b32 s33, 8192
    buffer_load_dwordx4 a[36:39], v14, s[4:7], s33 offen offset:1024 sc1
    v_mfma_f32_16x16x32_bf16 v[212:215], v[52:55], v[84:87], v[212:215]
    ds_read_b64_tr_b16 v[42:43], v6 offset:51200
    v_mfma_f32_16x16x32_bf16 v[244:247], v[52:55], v[88:91], v[244:247]
    s_waitcnt lgkmcnt(4)
    v_mfma_f32_16x16x32_bf16 v[136:139], v[56:59], v[76:79], v[136:139]
    ds_read_b64_tr_b16 v[44:45], v6 offset:53248
    v_mfma_f32_16x16x32_bf16 v[168:171], v[56:59], v[80:83], v[168:171]
    s_mov_b32 s33, 8192
    buffer_load_dwordx4 a[40:43], v14, s[4:7], s33 offen offset:2048 sc1
    v_mfma_f32_16x16x32_bf16 v[200:203], v[56:59], v[84:87], v[200:203]
    ds_read_b64_tr_b16 v[46:47], v6 offset:55296
    v_mfma_f32_16x16x32_bf16 v[232:235], v[56:59], v[88:91], v[232:235]
    s_waitcnt lgkmcnt(4)
    v_mfma_f32_16x16x32_bf16 v[152:155], v[252:255], v[76:79], v[152:155]
    ds_read_b64_tr_b16 v[48:49], v7 offset:49152
    v_mfma_f32_16x16x32_bf16 v[184:187], v[252:255], v[80:83], v[184:187]
    s_mov_b32 s33, 8192
    buffer_load_dwordx4 a[44:47], v14, s[4:7], s33 offen offset:3072 sc1
    v_mfma_f32_16x16x32_bf16 v[216:219], v[252:255], v[84:87], v[216:219]
    ds_read_b64_tr_b16 v[50:51], v7 offset:51200
    v_mfma_f32_16x16x32_bf16 v[248:251], v[252:255], v[88:91], v[248:251]
    s_waitcnt lgkmcnt(4)
    s_waitcnt vmcnt(19)
    v_mfma_f32_16x16x32_bf16 v[124:127], v[40:43], v[92:95], v[124:127]
    ds_read_b64_tr_b16 v[52:53], v7 offset:53248
    v_mfma_f32_16x16x32_bf16 v[156:159], v[40:43], v[96:99], v[156:159]
    s_mov_b32 s33, 11264
    buffer_load_dwordx4 v[76:79], v10, s[4:7], s33 offen sc1
    v_mfma_f32_16x16x32_bf16 v[188:191], v[40:43], v[100:103], v[188:191]
    ds_read_b64_tr_b16 v[54:55], v7 offset:55296
    v_mfma_f32_16x16x32_bf16 v[220:223], v[40:43], v[104:107], v[220:223]
    s_waitcnt lgkmcnt(4)
    v_mfma_f32_16x16x32_bf16 v[140:143], v[44:47], v[92:95], v[140:143]
    ds_read_b64_tr_b16 v[56:57], v8 offset:49152
    v_mfma_f32_16x16x32_bf16 v[172:175], v[44:47], v[96:99], v[172:175]
    s_mov_b32 s33, 32768
    buffer_load_dwordx4 v[80:83], v10, s[4:7], s33 offen sc1
    v_mfma_f32_16x16x32_bf16 v[204:207], v[44:47], v[100:103], v[204:207]
    ds_read_b64_tr_b16 v[58:59], v8 offset:51200
    v_mfma_f32_16x16x32_bf16 v[236:239], v[44:47], v[104:107], v[236:239]
    s_waitcnt lgkmcnt(4)
    v_mfma_f32_16x16x32_bf16 v[128:131], v[48:51], v[92:95], v[128:131]
    ds_read_b64_tr_b16 v[252:253], v8 offset:53248
    v_mfma_f32_16x16x32_bf16 v[160:163], v[48:51], v[96:99], v[160:163]
    s_mov_b32 s33, 54272
    buffer_load_dwordx4 v[84:87], v10, s[4:7], s33 offen sc1
    v_mfma_f32_16x16x32_bf16 v[192:195], v[48:51], v[100:103], v[192:195]
    ds_read_b64_tr_b16 v[254:255], v8 offset:55296
    v_mfma_f32_16x16x32_bf16 v[224:227], v[48:51], v[104:107], v[224:227]
    s_waitcnt lgkmcnt(4)
    v_mfma_f32_16x16x32_bf16 v[144:147], v[52:55], v[92:95], v[144:147]
    ds_read_b64_tr_b16 v[40:41], v9 offset:49152
    v_mfma_f32_16x16x32_bf16 v[176:179], v[52:55], v[96:99], v[176:179]
    s_mov_b32 s33, 75776
    buffer_load_dwordx4 v[88:91], v10, s[4:7], s33 offen sc1
    v_mfma_f32_16x16x32_bf16 v[208:211], v[52:55], v[100:103], v[208:211]
    ds_read_b64_tr_b16 v[42:43], v9 offset:51200
    v_mfma_f32_16x16x32_bf16 v[240:243], v[52:55], v[104:107], v[240:243]
    s_waitcnt lgkmcnt(4)
    v_mfma_f32_16x16x32_bf16 v[132:135], v[56:59], v[92:95], v[132:135]
    ds_read_b64_tr_b16 v[44:45], v9 offset:53248
    v_mfma_f32_16x16x32_bf16 v[164:167], v[56:59], v[96:99], v[164:167]
    s_mov_b32 s33, 12288
    buffer_load_dwordx4 a[48:51], v14, s[4:7], s33 offen offset:0 sc1
    v_mfma_f32_16x16x32_bf16 v[196:199], v[56:59], v[100:103], v[196:199]
    ds_read_b64_tr_b16 v[46:47], v9 offset:55296
    v_mfma_f32_16x16x32_bf16 v[228:231], v[56:59], v[104:107], v[228:231]
    s_waitcnt lgkmcnt(4)
    v_mfma_f32_16x16x32_bf16 v[148:151], v[252:255], v[92:95], v[148:151]
    ds_read_b64_tr_b16 v[48:49], v6 offset:57344
    v_mfma_f32_16x16x32_bf16 v[180:183], v[252:255], v[96:99], v[180:183]
    s_mov_b32 s33, 12288
    buffer_load_dwordx4 a[52:55], v14, s[4:7], s33 offen offset:1024 sc1
    v_mfma_f32_16x16x32_bf16 v[212:215], v[252:255], v[100:103], v[212:215]
    ds_read_b64_tr_b16 v[50:51], v6 offset:59392
    v_mfma_f32_16x16x32_bf16 v[244:247], v[252:255], v[104:107], v[244:247]
    s_waitcnt lgkmcnt(4)
    v_mfma_f32_16x16x32_bf16 v[136:139], v[40:43], v[92:95], v[136:139]
    ds_read_b64_tr_b16 v[52:53], v6 offset:61440
    v_mfma_f32_16x16x32_bf16 v[168:171], v[40:43], v[96:99], v[168:171]
    s_mov_b32 s33, 12288
    buffer_load_dwordx4 a[56:59], v14, s[4:7], s33 offen offset:2048 sc1
    v_mfma_f32_16x16x32_bf16 v[200:203], v[40:43], v[100:103], v[200:203]
    ds_read_b64_tr_b16 v[54:55], v6 offset:63488
    v_mfma_f32_16x16x32_bf16 v[232:235], v[40:43], v[104:107], v[232:235]
    s_waitcnt lgkmcnt(4)
    v_mfma_f32_16x16x32_bf16 v[152:155], v[44:47], v[92:95], v[152:155]
    ds_read_b64_tr_b16 v[56:57], v7 offset:57344
    v_mfma_f32_16x16x32_bf16 v[184:187], v[44:47], v[96:99], v[184:187]
    v_mfma_f32_16x16x32_bf16 v[216:219], v[44:47], v[100:103], v[216:219]
    ds_read_b64_tr_b16 v[58:59], v7 offset:59392
    v_mfma_f32_16x16x32_bf16 v[248:251], v[44:47], v[104:107], v[248:251]
    s_waitcnt lgkmcnt(4)
    s_waitcnt vmcnt(18)
    v_mfma_f32_16x16x32_bf16 v[124:127], v[48:51], v[108:111], v[124:127]
    ds_read_b64_tr_b16 v[252:253], v7 offset:61440
    v_mfma_f32_16x16x32_bf16 v[156:159], v[48:51], v[112:115], v[156:159]
    s_mov_b32 s33, 12288
    buffer_load_dwordx4 v[92:95], v10, s[4:7], s33 offen sc1
    v_mfma_f32_16x16x32_bf16 v[188:191], v[48:51], v[116:119], v[188:191]
    ds_read_b64_tr_b16 v[254:255], v7 offset:63488
    v_mfma_f32_16x16x32_bf16 v[220:223], v[48:51], v[120:123], v[220:223]
    s_waitcnt lgkmcnt(4)
    v_mfma_f32_16x16x32_bf16 v[140:143], v[52:55], v[108:111], v[140:143]
    ds_read_b64_tr_b16 v[40:41], v8 offset:57344
    v_mfma_f32_16x16x32_bf16 v[172:175], v[52:55], v[112:115], v[172:175]
    s_mov_b32 s33, 33792
    buffer_load_dwordx4 v[96:99], v10, s[4:7], s33 offen sc1
    v_mfma_f32_16x16x32_bf16 v[204:207], v[52:55], v[116:119], v[204:207]
    ds_read_b64_tr_b16 v[42:43], v8 offset:59392
    v_mfma_f32_16x16x32_bf16 v[236:239], v[52:55], v[120:123], v[236:239]
    s_waitcnt lgkmcnt(4)
    v_mfma_f32_16x16x32_bf16 v[128:131], v[56:59], v[108:111], v[128:131]
    ds_read_b64_tr_b16 v[44:45], v8 offset:61440
    v_mfma_f32_16x16x32_bf16 v[160:163], v[56:59], v[112:115], v[160:163]
    s_mov_b32 s33, 55296
    buffer_load_dwordx4 v[100:103], v10, s[4:7], s33 offen sc1
    v_mfma_f32_16x16x32_bf16 v[192:195], v[56:59], v[116:119], v[192:195]
    ds_read_b64_tr_b16 v[46:47], v8 offset:63488
    v_mfma_f32_16x16x32_bf16 v[224:227], v[56:59], v[120:123], v[224:227]
    s_waitcnt lgkmcnt(4)
    v_mfma_f32_16x16x32_bf16 v[144:147], v[252:255], v[108:111], v[144:147]
    ds_read_b64_tr_b16 v[48:49], v9 offset:57344
    v_mfma_f32_16x16x32_bf16 v[176:179], v[252:255], v[112:115], v[176:179]
    s_mov_b32 s33, 76800
    buffer_load_dwordx4 v[104:107], v10, s[4:7], s33 offen sc1
    v_mfma_f32_16x16x32_bf16 v[208:211], v[252:255], v[116:119], v[208:211]
    ds_read_b64_tr_b16 v[50:51], v9 offset:59392
    v_mfma_f32_16x16x32_bf16 v[240:243], v[252:255], v[120:123], v[240:243]
    s_waitcnt lgkmcnt(4)
    v_mfma_f32_16x16x32_bf16 v[132:135], v[40:43], v[108:111], v[132:135]
    ds_read_b64_tr_b16 v[52:53], v9 offset:61440
    v_mfma_f32_16x16x32_bf16 v[164:167], v[40:43], v[112:115], v[164:167]
    s_mov_b32 s33, 12288
    buffer_load_dwordx4 a[60:63], v14, s[4:7], s33 offen offset:3072 sc1
    v_mfma_f32_16x16x32_bf16 v[196:199], v[40:43], v[116:119], v[196:199]
    ds_read_b64_tr_b16 v[54:55], v9 offset:63488
    v_mfma_f32_16x16x32_bf16 v[228:231], v[40:43], v[120:123], v[228:231]
    s_waitcnt lgkmcnt(4)
    v_mfma_f32_16x16x32_bf16 v[148:151], v[44:47], v[108:111], v[148:151]
    v_add_u32 v6, 0x10000, v6
    v_add_u32 v7, 0x10000, v7
    v_add_u32 v8, 0x10000, v8
    v_add_u32 v9, 0x10000, v9
    ds_read_b64_tr_b16 v[56:57], v6 offset:16384
    v_mfma_f32_16x16x32_bf16 v[180:183], v[44:47], v[112:115], v[180:183]
    s_mov_b32 s33, 16384
    buffer_load_dwordx4 a[64:67], v14, s[4:7], s33 offen offset:0 sc1
    v_mfma_f32_16x16x32_bf16 v[212:215], v[44:47], v[116:119], v[212:215]
    ds_read_b64_tr_b16 v[58:59], v6 offset:18432
    v_mfma_f32_16x16x32_bf16 v[244:247], v[44:47], v[120:123], v[244:247]
    s_waitcnt lgkmcnt(4)
    v_mfma_f32_16x16x32_bf16 v[136:139], v[48:51], v[108:111], v[136:139]
    ds_read_b64_tr_b16 v[252:253], v6 offset:20480
    v_mfma_f32_16x16x32_bf16 v[168:171], v[48:51], v[112:115], v[168:171]
    s_mov_b32 s33, 16384
    buffer_load_dwordx4 a[68:71], v14, s[4:7], s33 offen offset:1024 sc1
    v_mfma_f32_16x16x32_bf16 v[200:203], v[48:51], v[116:119], v[200:203]
    ds_read_b64_tr_b16 v[254:255], v6 offset:22528
    v_mfma_f32_16x16x32_bf16 v[232:235], v[48:51], v[120:123], v[232:235]
    s_waitcnt lgkmcnt(4)
    v_mfma_f32_16x16x32_bf16 v[152:155], v[52:55], v[108:111], v[152:155]
    ds_read_b64_tr_b16 v[40:41], v7 offset:16384
    v_mfma_f32_16x16x32_bf16 v[184:187], v[52:55], v[112:115], v[184:187]
    s_mov_b32 s33, 16384
    buffer_load_dwordx4 a[72:75], v14, s[4:7], s33 offen offset:2048 sc1
    v_mfma_f32_16x16x32_bf16 v[216:219], v[52:55], v[116:119], v[216:219]
    ds_read_b64_tr_b16 v[42:43], v7 offset:18432
    v_mfma_f32_16x16x32_bf16 v[248:251], v[52:55], v[120:123], v[248:251]
    s_waitcnt lgkmcnt(4)
    s_waitcnt vmcnt(19)
    v_mfma_f32_16x16x32_bf16 v[124:127], v[56:59], v[60:63], v[124:127]
    ds_read_b64_tr_b16 v[44:45], v7 offset:20480
    v_mfma_f32_16x16x32_bf16 v[156:159], v[56:59], v[64:67], v[156:159]
    s_mov_b32 s33, 13312
    buffer_load_dwordx4 v[108:111], v10, s[4:7], s33 offen sc1
    v_mfma_f32_16x16x32_bf16 v[188:191], v[56:59], v[68:71], v[188:191]
    ds_read_b64_tr_b16 v[46:47], v7 offset:22528
    v_mfma_f32_16x16x32_bf16 v[220:223], v[56:59], v[72:75], v[220:223]
    s_waitcnt lgkmcnt(4)
    v_mfma_f32_16x16x32_bf16 v[140:143], v[252:255], v[60:63], v[140:143]
    ds_read_b64_tr_b16 v[48:49], v8 offset:16384
    v_mfma_f32_16x16x32_bf16 v[172:175], v[252:255], v[64:67], v[172:175]
    s_mov_b32 s33, 34816
    buffer_load_dwordx4 v[112:115], v10, s[4:7], s33 offen sc1
    v_mfma_f32_16x16x32_bf16 v[204:207], v[252:255], v[68:71], v[204:207]
    ds_read_b64_tr_b16 v[50:51], v8 offset:18432
    v_mfma_f32_16x16x32_bf16 v[236:239], v[252:255], v[72:75], v[236:239]
    s_waitcnt lgkmcnt(4)
    v_mfma_f32_16x16x32_bf16 v[128:131], v[40:43], v[60:63], v[128:131]
    ds_read_b64_tr_b16 v[52:53], v8 offset:20480
    v_mfma_f32_16x16x32_bf16 v[160:163], v[40:43], v[64:67], v[160:163]
    s_mov_b32 s33, 56320
    buffer_load_dwordx4 v[116:119], v10, s[4:7], s33 offen sc1
    v_mfma_f32_16x16x32_bf16 v[192:195], v[40:43], v[68:71], v[192:195]
    ds_read_b64_tr_b16 v[54:55], v8 offset:22528
    v_mfma_f32_16x16x32_bf16 v[224:227], v[40:43], v[72:75], v[224:227]
    s_waitcnt lgkmcnt(4)
    v_mfma_f32_16x16x32_bf16 v[144:147], v[44:47], v[60:63], v[144:147]
    ds_read_b64_tr_b16 v[56:57], v9 offset:16384
    v_mfma_f32_16x16x32_bf16 v[176:179], v[44:47], v[64:67], v[176:179]
    s_mov_b32 s33, 77824
    buffer_load_dwordx4 v[120:123], v10, s[4:7], s33 offen sc1
    v_mfma_f32_16x16x32_bf16 v[208:211], v[44:47], v[68:71], v[208:211]
    ds_read_b64_tr_b16 v[58:59], v9 offset:18432
    v_mfma_f32_16x16x32_bf16 v[240:243], v[44:47], v[72:75], v[240:243]
    s_waitcnt lgkmcnt(4)
    v_mfma_f32_16x16x32_bf16 v[132:135], v[48:51], v[60:63], v[132:135]
    ds_read_b64_tr_b16 v[252:253], v9 offset:20480
    v_mfma_f32_16x16x32_bf16 v[164:167], v[48:51], v[64:67], v[164:167]
    s_add_u32 m0, s63, 73728
    s_mov_b32 s33, 995328
    buffer_load_dwordx4 v12, s[24:27], s33 offen lds
    buffer_load_dwordx4 v13, s[24:27], s33 offen offset:1024 lds
    v_mfma_f32_16x16x32_bf16 v[196:199], v[48:51], v[68:71], v[196:199]
    ds_read_b64_tr_b16 v[254:255], v9 offset:22528
    v_mfma_f32_16x16x32_bf16 v[228:231], v[48:51], v[72:75], v[228:231]
    s_waitcnt lgkmcnt(4)
    v_mfma_f32_16x16x32_bf16 v[148:151], v[52:55], v[60:63], v[148:151]
    ds_read_b64_tr_b16 v[40:41], v6 offset:24576
    v_mfma_f32_16x16x32_bf16 v[180:183], v[52:55], v[64:67], v[180:183]
    v_mfma_f32_16x16x32_bf16 v[212:215], v[52:55], v[68:71], v[212:215]
    ds_read_b64_tr_b16 v[42:43], v6 offset:26624
    v_mfma_f32_16x16x32_bf16 v[244:247], v[52:55], v[72:75], v[244:247]
    s_waitcnt lgkmcnt(4)
    v_mfma_f32_16x16x32_bf16 v[136:139], v[56:59], v[60:63], v[136:139]
    ds_read_b64_tr_b16 v[44:45], v6 offset:28672
    v_mfma_f32_16x16x32_bf16 v[168:171], v[56:59], v[64:67], v[168:171]
    s_mov_b32 s33, 16384
    buffer_load_dwordx4 a[76:79], v14, s[4:7], s33 offen offset:3072 sc1
    v_mfma_f32_16x16x32_bf16 v[200:203], v[56:59], v[68:71], v[200:203]
    ds_read_b64_tr_b16 v[46:47], v6 offset:30720
    v_mfma_f32_16x16x32_bf16 v[232:235], v[56:59], v[72:75], v[232:235]
    s_waitcnt lgkmcnt(4)
    v_mfma_f32_16x16x32_bf16 v[152:155], v[252:255], v[60:63], v[152:155]
    ds_read_b64_tr_b16 v[48:49], v7 offset:24576
    v_mfma_f32_16x16x32_bf16 v[184:187], v[252:255], v[64:67], v[184:187]
    s_mov_b32 s33, 20480
    buffer_load_dwordx4 a[80:83], v14, s[4:7], s33 offen offset:0 sc1
    v_mfma_f32_16x16x32_bf16 v[216:219], v[252:255], v[68:71], v[216:219]
    ds_read_b64_tr_b16 v[50:51], v7 offset:26624
    v_mfma_f32_16x16x32_bf16 v[248:251], v[252:255], v[72:75], v[248:251]
    s_waitcnt lgkmcnt(4)
    s_waitcnt vmcnt(19)
    v_mfma_f32_16x16x32_bf16 v[124:127], v[40:43], v[76:79], v[124:127]
    ds_read_b64_tr_b16 v[52:53], v7 offset:28672
    v_mfma_f32_16x16x32_bf16 v[156:159], v[40:43], v[80:83], v[156:159]
    s_mov_b32 s33, 14336
    buffer_load_dwordx4 v[60:63], v10, s[4:7], s33 offen sc1
    v_mfma_f32_16x16x32_bf16 v[188:191], v[40:43], v[84:87], v[188:191]
    ds_read_b64_tr_b16 v[54:55], v7 offset:30720
    v_mfma_f32_16x16x32_bf16 v[220:223], v[40:43], v[88:91], v[220:223]
    s_waitcnt lgkmcnt(4)
    v_mfma_f32_16x16x32_bf16 v[140:143], v[44:47], v[76:79], v[140:143]
    ds_read_b64_tr_b16 v[56:57], v8 offset:24576
    v_mfma_f32_16x16x32_bf16 v[172:175], v[44:47], v[80:83], v[172:175]
    s_mov_b32 s33, 35840
    buffer_load_dwordx4 v[64:67], v10, s[4:7], s33 offen sc1
    v_mfma_f32_16x16x32_bf16 v[204:207], v[44:47], v[84:87], v[204:207]
    ds_read_b64_tr_b16 v[58:59], v8 offset:26624
    v_mfma_f32_16x16x32_bf16 v[236:239], v[44:47], v[88:91], v[236:239]
    s_waitcnt lgkmcnt(4)
    v_mfma_f32_16x16x32_bf16 v[128:131], v[48:51], v[76:79], v[128:131]
    ds_read_b64_tr_b16 v[252:253], v8 offset:28672
    v_mfma_f32_16x16x32_bf16 v[160:163], v[48:51], v[80:83], v[160:163]
    s_mov_b32 s33, 57344
    buffer_load_dwordx4 v[68:71], v10, s[4:7], s33 offen sc1
    v_mfma_f32_16x16x32_bf16 v[192:195], v[48:51], v[84:87], v[192:195]
    ds_read_b64_tr_b16 v[254:255], v8 offset:30720
    v_mfma_f32_16x16x32_bf16 v[224:227], v[48:51], v[88:91], v[224:227]
    s_waitcnt lgkmcnt(4)
    v_mfma_f32_16x16x32_bf16 v[144:147], v[52:55], v[76:79], v[144:147]
    ds_read_b64_tr_b16 v[40:41], v9 offset:24576
    v_mfma_f32_16x16x32_bf16 v[176:179], v[52:55], v[80:83], v[176:179]
    s_mov_b32 s33, 78848
    buffer_load_dwordx4 v[72:75], v10, s[4:7], s33 offen sc1
    v_mfma_f32_16x16x32_bf16 v[208:211], v[52:55], v[84:87], v[208:211]
    ds_read_b64_tr_b16 v[42:43], v9 offset:26624
    v_mfma_f32_16x16x32_bf16 v[240:243], v[52:55], v[88:91], v[240:243]
    s_waitcnt lgkmcnt(4)
    v_mfma_f32_16x16x32_bf16 v[132:135], v[56:59], v[76:79], v[132:135]
    ds_read_b64_tr_b16 v[44:45], v9 offset:28672
    v_mfma_f32_16x16x32_bf16 v[164:167], v[56:59], v[80:83], v[164:167]
    s_mov_b32 s33, 20480
    buffer_load_dwordx4 a[84:87], v14, s[4:7], s33 offen offset:1024 sc1
    v_mfma_f32_16x16x32_bf16 v[196:199], v[56:59], v[84:87], v[196:199]
    ds_read_b64_tr_b16 v[46:47], v9 offset:30720
    v_mfma_f32_16x16x32_bf16 v[228:231], v[56:59], v[88:91], v[228:231]
    s_waitcnt lgkmcnt(4)
    v_mfma_f32_16x16x32_bf16 v[148:151], v[252:255], v[76:79], v[148:151]
    ds_read_b64_tr_b16 v[48:49], v6 offset:32768
    v_mfma_f32_16x16x32_bf16 v[180:183], v[252:255], v[80:83], v[180:183]
    s_mov_b32 s33, 20480
    buffer_load_dwordx4 a[88:91], v14, s[4:7], s33 offen offset:2048 sc1
    v_mfma_f32_16x16x32_bf16 v[212:215], v[252:255], v[84:87], v[212:215]
    ds_read_b64_tr_b16 v[50:51], v6 offset:34816
    v_mfma_f32_16x16x32_bf16 v[244:247], v[252:255], v[88:91], v[244:247]
    s_waitcnt lgkmcnt(4)
    v_mfma_f32_16x16x32_bf16 v[136:139], v[40:43], v[76:79], v[136:139]
    ds_read_b64_tr_b16 v[52:53], v6 offset:36864
    v_mfma_f32_16x16x32_bf16 v[168:171], v[40:43], v[80:83], v[168:171]
    s_mov_b32 s33, 20480
    buffer_load_dwordx4 a[92:95], v14, s[4:7], s33 offen offset:3072 sc1
    v_mfma_f32_16x16x32_bf16 v[200:203], v[40:43], v[84:87], v[200:203]
    ds_read_b64_tr_b16 v[54:55], v6 offset:38912
    v_mfma_f32_16x16x32_bf16 v[232:235], v[40:43], v[88:91], v[232:235]
    s_waitcnt lgkmcnt(4)
    v_mfma_f32_16x16x32_bf16 v[152:155], v[44:47], v[76:79], v[152:155]
    ds_read_b64_tr_b16 v[56:57], v7 offset:32768
    v_mfma_f32_16x16x32_bf16 v[184:187], v[44:47], v[80:83], v[184:187]
    v_mfma_f32_16x16x32_bf16 v[216:219], v[44:47], v[84:87], v[216:219]
    ds_read_b64_tr_b16 v[58:59], v7 offset:34816
    v_mfma_f32_16x16x32_bf16 v[248:251], v[44:47], v[88:91], v[248:251]
    s_waitcnt lgkmcnt(4)
    s_waitcnt vmcnt(19)
    v_mfma_f32_16x16x32_bf16 v[124:127], v[48:51], v[92:95], v[124:127]
    ds_read_b64_tr_b16 v[252:253], v7 offset:36864
    v_mfma_f32_16x16x32_bf16 v[156:159], v[48:51], v[96:99], v[156:159]
    s_mov_b32 s33, 15360
    buffer_load_dwordx4 v[76:79], v10, s[4:7], s33 offen sc1
    v_mfma_f32_16x16x32_bf16 v[188:191], v[48:51], v[100:103], v[188:191]
    ds_read_b64_tr_b16 v[254:255], v7 offset:38912
    v_mfma_f32_16x16x32_bf16 v[220:223], v[48:51], v[104:107], v[220:223]
    s_waitcnt lgkmcnt(4)
    v_mfma_f32_16x16x32_bf16 v[140:143], v[52:55], v[92:95], v[140:143]
    ds_read_b64_tr_b16 v[40:41], v8 offset:32768
    v_mfma_f32_16x16x32_bf16 v[172:175], v[52:55], v[96:99], v[172:175]
    s_mov_b32 s33, 36864
    buffer_load_dwordx4 v[80:83], v10, s[4:7], s33 offen sc1
    v_mfma_f32_16x16x32_bf16 v[204:207], v[52:55], v[100:103], v[204:207]
    ds_read_b64_tr_b16 v[42:43], v8 offset:34816
    v_mfma_f32_16x16x32_bf16 v[236:239], v[52:55], v[104:107], v[236:239]
    s_waitcnt lgkmcnt(4)
    v_mfma_f32_16x16x32_bf16 v[128:131], v[56:59], v[92:95], v[128:131]
    ds_read_b64_tr_b16 v[44:45], v8 offset:36864
    v_mfma_f32_16x16x32_bf16 v[160:163], v[56:59], v[96:99], v[160:163]
    s_mov_b32 s33, 58368
    buffer_load_dwordx4 v[84:87], v10, s[4:7], s33 offen sc1
    v_mfma_f32_16x16x32_bf16 v[192:195], v[56:59], v[100:103], v[192:195]
    ds_read_b64_tr_b16 v[46:47], v8 offset:38912
    v_mfma_f32_16x16x32_bf16 v[224:227], v[56:59], v[104:107], v[224:227]
    s_waitcnt lgkmcnt(4)
    v_mfma_f32_16x16x32_bf16 v[144:147], v[252:255], v[92:95], v[144:147]
    ds_read_b64_tr_b16 v[48:49], v9 offset:32768
    v_mfma_f32_16x16x32_bf16 v[176:179], v[252:255], v[96:99], v[176:179]
    s_mov_b32 s33, 79872
    buffer_load_dwordx4 v[88:91], v10, s[4:7], s33 offen sc1
    v_mfma_f32_16x16x32_bf16 v[208:211], v[252:255], v[100:103], v[208:211]
    ds_read_b64_tr_b16 v[50:51], v9 offset:34816
    v_mfma_f32_16x16x32_bf16 v[240:243], v[252:255], v[104:107], v[240:243]
    s_waitcnt lgkmcnt(4)
    v_mfma_f32_16x16x32_bf16 v[132:135], v[40:43], v[92:95], v[132:135]
    ds_read_b64_tr_b16 v[52:53], v9 offset:36864
    v_mfma_f32_16x16x32_bf16 v[164:167], v[40:43], v[96:99], v[164:167]
    s_mov_b32 s33, 24576
    buffer_load_dwordx4 a[96:99], v14, s[4:7], s33 offen offset:0 sc1
    v_mfma_f32_16x16x32_bf16 v[196:199], v[40:43], v[100:103], v[196:199]
    ds_read_b64_tr_b16 v[54:55], v9 offset:38912
    v_mfma_f32_16x16x32_bf16 v[228:231], v[40:43], v[104:107], v[228:231]
    s_waitcnt lgkmcnt(4)
    v_mfma_f32_16x16x32_bf16 v[148:151], v[44:47], v[92:95], v[148:151]
    ds_read_b64_tr_b16 v[56:57], v6 offset:40960
    v_mfma_f32_16x16x32_bf16 v[180:183], v[44:47], v[96:99], v[180:183]
    s_mov_b32 s33, 24576
    buffer_load_dwordx4 a[100:103], v14, s[4:7], s33 offen offset:1024 sc1
    v_mfma_f32_16x16x32_bf16 v[212:215], v[44:47], v[100:103], v[212:215]
    ds_read_b64_tr_b16 v[58:59], v6 offset:43008
    v_mfma_f32_16x16x32_bf16 v[244:247], v[44:47], v[104:107], v[244:247]
    s_waitcnt lgkmcnt(4)
    v_mfma_f32_16x16x32_bf16 v[136:139], v[48:51], v[92:95], v[136:139]
    ds_read_b64_tr_b16 v[252:253], v6 offset:45056
    v_mfma_f32_16x16x32_bf16 v[168:171], v[48:51], v[96:99], v[168:171]
    s_mov_b32 s33, 24576
    buffer_load_dwordx4 a[104:107], v14, s[4:7], s33 offen offset:2048 sc1
    v_mfma_f32_16x16x32_bf16 v[200:203], v[48:51], v[100:103], v[200:203]
    ds_read_b64_tr_b16 v[254:255], v6 offset:47104
    v_mfma_f32_16x16x32_bf16 v[232:235], v[48:51], v[104:107], v[232:235]
    s_waitcnt lgkmcnt(4)
    v_mfma_f32_16x16x32_bf16 v[152:155], v[52:55], v[92:95], v[152:155]
    ds_read_b64_tr_b16 v[40:41], v7 offset:40960
    v_mfma_f32_16x16x32_bf16 v[184:187], v[52:55], v[96:99], v[184:187]
    s_mov_b32 s33, 24576
    buffer_load_dwordx4 a[108:111], v14, s[4:7], s33 offen offset:3072 sc1
    v_mfma_f32_16x16x32_bf16 v[216:219], v[52:55], v[100:103], v[216:219]
    ds_read_b64_tr_b16 v[42:43], v7 offset:43008
    v_mfma_f32_16x16x32_bf16 v[248:251], v[52:55], v[104:107], v[248:251]
    s_waitcnt lgkmcnt(4)
    s_waitcnt vmcnt(19)
    v_mfma_f32_16x16x32_bf16 v[124:127], v[56:59], v[108:111], v[124:127]
    ds_read_b64_tr_b16 v[44:45], v7 offset:45056
    v_mfma_f32_16x16x32_bf16 v[156:159], v[56:59], v[112:115], v[156:159]
    s_mov_b32 s33, 16384
    buffer_load_dwordx4 v[92:95], v10, s[4:7], s33 offen sc1
    v_mfma_f32_16x16x32_bf16 v[188:191], v[56:59], v[116:119], v[188:191]
    ds_read_b64_tr_b16 v[46:47], v7 offset:47104
    v_mfma_f32_16x16x32_bf16 v[220:223], v[56:59], v[120:123], v[220:223]
    s_waitcnt lgkmcnt(4)
    v_mfma_f32_16x16x32_bf16 v[140:143], v[252:255], v[108:111], v[140:143]
    ds_read_b64_tr_b16 v[48:49], v8 offset:40960
    v_mfma_f32_16x16x32_bf16 v[172:175], v[252:255], v[112:115], v[172:175]
    s_mov_b32 s33, 37888
    buffer_load_dwordx4 v[96:99], v10, s[4:7], s33 offen sc1
    v_mfma_f32_16x16x32_bf16 v[204:207], v[252:255], v[116:119], v[204:207]
    ds_read_b64_tr_b16 v[50:51], v8 offset:43008
    v_mfma_f32_16x16x32_bf16 v[236:239], v[252:255], v[120:123], v[236:239]
    s_waitcnt lgkmcnt(4)
    v_mfma_f32_16x16x32_bf16 v[128:131], v[40:43], v[108:111], v[128:131]
    ds_read_b64_tr_b16 v[52:53], v8 offset:45056
    v_mfma_f32_16x16x32_bf16 v[160:163], v[40:43], v[112:115], v[160:163]
    s_mov_b32 s33, 59392
    buffer_load_dwordx4 v[100:103], v10, s[4:7], s33 offen sc1
    v_mfma_f32_16x16x32_bf16 v[192:195], v[40:43], v[116:119], v[192:195]
    ds_read_b64_tr_b16 v[54:55], v8 offset:47104
    v_mfma_f32_16x16x32_bf16 v[224:227], v[40:43], v[120:123], v[224:227]
    s_waitcnt lgkmcnt(4)
    v_mfma_f32_16x16x32_bf16 v[144:147], v[44:47], v[108:111], v[144:147]
    ds_read_b64_tr_b16 v[56:57], v9 offset:40960
    v_mfma_f32_16x16x32_bf16 v[176:179], v[44:47], v[112:115], v[176:179]
    s_mov_b32 s33, 80896
    buffer_load_dwordx4 v[104:107], v10, s[4:7], s33 offen sc1
    v_mfma_f32_16x16x32_bf16 v[208:211], v[44:47], v[116:119], v[208:211]
    ds_read_b64_tr_b16 v[58:59], v9 offset:43008
    v_mfma_f32_16x16x32_bf16 v[240:243], v[44:47], v[120:123], v[240:243]
    s_waitcnt lgkmcnt(4)
    v_mfma_f32_16x16x32_bf16 v[132:135], v[48:51], v[108:111], v[132:135]
    ds_read_b64_tr_b16 v[252:253], v9 offset:45056
    v_mfma_f32_16x16x32_bf16 v[164:167], v[48:51], v[112:115], v[164:167]
    s_mov_b32 s33, 28672
    buffer_load_dwordx4 a[112:115], v14, s[4:7], s33 offen offset:0 sc1
    v_mfma_f32_16x16x32_bf16 v[196:199], v[48:51], v[116:119], v[196:199]
    ds_read_b64_tr_b16 v[254:255], v9 offset:47104
    v_mfma_f32_16x16x32_bf16 v[228:231], v[48:51], v[120:123], v[228:231]
    s_waitcnt lgkmcnt(4)
    v_mfma_f32_16x16x32_bf16 v[148:151], v[52:55], v[108:111], v[148:151]
    ds_read_b64_tr_b16 v[40:41], v6 offset:49152
    v_mfma_f32_16x16x32_bf16 v[180:183], v[52:55], v[112:115], v[180:183]
    s_mov_b32 s33, 28672
    buffer_load_dwordx4 a[116:119], v14, s[4:7], s33 offen offset:1024 sc1
    v_mfma_f32_16x16x32_bf16 v[212:215], v[52:55], v[116:119], v[212:215]
    ds_read_b64_tr_b16 v[42:43], v6 offset:51200
    v_mfma_f32_16x16x32_bf16 v[244:247], v[52:55], v[120:123], v[244:247]
    s_waitcnt lgkmcnt(4)
    v_mfma_f32_16x16x32_bf16 v[136:139], v[56:59], v[108:111], v[136:139]
    ds_read_b64_tr_b16 v[44:45], v6 offset:53248
    v_mfma_f32_16x16x32_bf16 v[168:171], v[56:59], v[112:115], v[168:171]
    s_mov_b32 s33, 28672
    buffer_load_dwordx4 a[120:123], v14, s[4:7], s33 offen offset:2048 sc1
    v_mfma_f32_16x16x32_bf16 v[200:203], v[56:59], v[116:119], v[200:203]
    ds_read_b64_tr_b16 v[46:47], v6 offset:55296
    v_mfma_f32_16x16x32_bf16 v[232:235], v[56:59], v[120:123], v[232:235]
    s_waitcnt lgkmcnt(4)
    v_mfma_f32_16x16x32_bf16 v[152:155], v[252:255], v[108:111], v[152:155]
    ds_read_b64_tr_b16 v[48:49], v7 offset:49152
    v_mfma_f32_16x16x32_bf16 v[184:187], v[252:255], v[112:115], v[184:187]
    v_mfma_f32_16x16x32_bf16 v[216:219], v[252:255], v[116:119], v[216:219]
    ds_read_b64_tr_b16 v[50:51], v7 offset:51200
    v_mfma_f32_16x16x32_bf16 v[248:251], v[252:255], v[120:123], v[248:251]
    s_waitcnt lgkmcnt(4)
    s_waitcnt vmcnt(18)
    v_mfma_f32_16x16x32_bf16 v[124:127], v[40:43], v[60:63], v[124:127]
    ds_read_b64_tr_b16 v[52:53], v7 offset:53248
    v_mfma_f32_16x16x32_bf16 v[156:159], v[40:43], v[64:67], v[156:159]
    s_mov_b32 s33, 17408
    buffer_load_dwordx4 v[108:111], v10, s[4:7], s33 offen sc1
    v_mfma_f32_16x16x32_bf16 v[188:191], v[40:43], v[68:71], v[188:191]
    ds_read_b64_tr_b16 v[54:55], v7 offset:55296
    v_mfma_f32_16x16x32_bf16 v[220:223], v[40:43], v[72:75], v[220:223]
    s_waitcnt lgkmcnt(4)
    v_mfma_f32_16x16x32_bf16 v[140:143], v[44:47], v[60:63], v[140:143]
    ds_read_b64_tr_b16 v[56:57], v8 offset:49152
    v_mfma_f32_16x16x32_bf16 v[172:175], v[44:47], v[64:67], v[172:175]
    s_mov_b32 s33, 38912
    buffer_load_dwordx4 v[112:115], v10, s[4:7], s33 offen sc1
    v_mfma_f32_16x16x32_bf16 v[204:207], v[44:47], v[68:71], v[204:207]
    ds_read_b64_tr_b16 v[58:59], v8 offset:51200
    v_mfma_f32_16x16x32_bf16 v[236:239], v[44:47], v[72:75], v[236:239]
    s_waitcnt lgkmcnt(4)
    v_mfma_f32_16x16x32_bf16 v[128:131], v[48:51], v[60:63], v[128:131]
    ds_read_b64_tr_b16 v[252:253], v8 offset:53248
    v_mfma_f32_16x16x32_bf16 v[160:163], v[48:51], v[64:67], v[160:163]
    s_mov_b32 s33, 60416
    buffer_load_dwordx4 v[116:119], v10, s[4:7], s33 offen sc1
    v_mfma_f32_16x16x32_bf16 v[192:195], v[48:51], v[68:71], v[192:195]
    ds_read_b64_tr_b16 v[254:255], v8 offset:55296
    v_mfma_f32_16x16x32_bf16 v[224:227], v[48:51], v[72:75], v[224:227]
    s_waitcnt lgkmcnt(4)
    v_mfma_f32_16x16x32_bf16 v[144:147], v[52:55], v[60:63], v[144:147]
    ds_read_b64_tr_b16 v[40:41], v9 offset:49152
    v_mfma_f32_16x16x32_bf16 v[176:179], v[52:55], v[64:67], v[176:179]
    s_mov_b32 s33, 81920
    buffer_load_dwordx4 v[120:123], v10, s[4:7], s33 offen sc1
    v_mfma_f32_16x16x32_bf16 v[208:211], v[52:55], v[68:71], v[208:211]
    ds_read_b64_tr_b16 v[42:43], v9 offset:51200
    v_mfma_f32_16x16x32_bf16 v[240:243], v[52:55], v[72:75], v[240:243]
    s_waitcnt lgkmcnt(4)
    v_mfma_f32_16x16x32_bf16 v[132:135], v[56:59], v[60:63], v[132:135]
    ds_read_b64_tr_b16 v[44:45], v9 offset:53248
    v_mfma_f32_16x16x32_bf16 v[164:167], v[56:59], v[64:67], v[164:167]
    s_mov_b32 s33, 28672
    buffer_load_dwordx4 a[124:127], v14, s[4:7], s33 offen offset:3072 sc1
    v_mfma_f32_16x16x32_bf16 v[196:199], v[56:59], v[68:71], v[196:199]
    ds_read_b64_tr_b16 v[46:47], v9 offset:55296
    v_mfma_f32_16x16x32_bf16 v[228:231], v[56:59], v[72:75], v[228:231]
    s_waitcnt lgkmcnt(4)
    v_mfma_f32_16x16x32_bf16 v[148:151], v[252:255], v[60:63], v[148:151]
    ds_read_b64_tr_b16 v[48:49], v6 offset:57344
    v_mfma_f32_16x16x32_bf16 v[180:183], v[252:255], v[64:67], v[180:183]
    s_mov_b32 s33, 32768
    buffer_load_dwordx4 a[128:131], v14, s[4:7], s33 offen offset:0 sc1
    v_mfma_f32_16x16x32_bf16 v[212:215], v[252:255], v[68:71], v[212:215]
    ds_read_b64_tr_b16 v[50:51], v6 offset:59392
    v_mfma_f32_16x16x32_bf16 v[244:247], v[252:255], v[72:75], v[244:247]
    s_waitcnt lgkmcnt(4)
    v_mfma_f32_16x16x32_bf16 v[136:139], v[40:43], v[60:63], v[136:139]
    ds_read_b64_tr_b16 v[52:53], v6 offset:61440
    v_mfma_f32_16x16x32_bf16 v[168:171], v[40:43], v[64:67], v[168:171]
    s_mov_b32 s33, 32768
    buffer_load_dwordx4 a[132:135], v14, s[4:7], s33 offen offset:1024 sc1
    v_mfma_f32_16x16x32_bf16 v[200:203], v[40:43], v[68:71], v[200:203]
    ds_read_b64_tr_b16 v[54:55], v6 offset:63488
    v_mfma_f32_16x16x32_bf16 v[232:235], v[40:43], v[72:75], v[232:235]
    s_waitcnt lgkmcnt(4)
    v_mfma_f32_16x16x32_bf16 v[152:155], v[44:47], v[60:63], v[152:155]
    ds_read_b64_tr_b16 v[56:57], v7 offset:57344
    v_mfma_f32_16x16x32_bf16 v[184:187], v[44:47], v[64:67], v[184:187]
    s_mov_b32 s33, 32768
    buffer_load_dwordx4 a[136:139], v14, s[4:7], s33 offen offset:2048 sc1
    v_mfma_f32_16x16x32_bf16 v[216:219], v[44:47], v[68:71], v[216:219]
    ds_read_b64_tr_b16 v[58:59], v7 offset:59392
    v_mfma_f32_16x16x32_bf16 v[248:251], v[44:47], v[72:75], v[248:251]
    s_waitcnt lgkmcnt(4)
    s_waitcnt vmcnt(19)
    v_mfma_f32_16x16x32_bf16 v[124:127], v[48:51], v[76:79], v[124:127]
    ds_read_b64_tr_b16 v[252:253], v7 offset:61440
    v_mfma_f32_16x16x32_bf16 v[156:159], v[48:51], v[80:83], v[156:159]
    s_mov_b32 s33, 18432
    buffer_load_dwordx4 v[60:63], v10, s[4:7], s33 offen sc1
    v_mfma_f32_16x16x32_bf16 v[188:191], v[48:51], v[84:87], v[188:191]
    ds_read_b64_tr_b16 v[254:255], v7 offset:63488
    v_mfma_f32_16x16x32_bf16 v[220:223], v[48:51], v[88:91], v[220:223]
    s_waitcnt lgkmcnt(4)
    v_mfma_f32_16x16x32_bf16 v[140:143], v[52:55], v[76:79], v[140:143]
    ds_read_b64_tr_b16 v[40:41], v8 offset:57344
    v_mfma_f32_16x16x32_bf16 v[172:175], v[52:55], v[80:83], v[172:175]
    s_mov_b32 s33, 39936
    buffer_load_dwordx4 v[64:67], v10, s[4:7], s33 offen sc1
    v_mfma_f32_16x16x32_bf16 v[204:207], v[52:55], v[84:87], v[204:207]
    ds_read_b64_tr_b16 v[42:43], v8 offset:59392
    v_mfma_f32_16x16x32_bf16 v[236:239], v[52:55], v[88:91], v[236:239]
    s_waitcnt lgkmcnt(4)
    v_mfma_f32_16x16x32_bf16 v[128:131], v[56:59], v[76:79], v[128:131]
    ds_read_b64_tr_b16 v[44:45], v8 offset:61440
    v_mfma_f32_16x16x32_bf16 v[160:163], v[56:59], v[80:83], v[160:163]
    s_mov_b32 s33, 61440
    buffer_load_dwordx4 v[68:71], v10, s[4:7], s33 offen sc1
    v_mfma_f32_16x16x32_bf16 v[192:195], v[56:59], v[84:87], v[192:195]
    ds_read_b64_tr_b16 v[46:47], v8 offset:63488
    v_mfma_f32_16x16x32_bf16 v[224:227], v[56:59], v[88:91], v[224:227]
    s_waitcnt lgkmcnt(4)
    v_mfma_f32_16x16x32_bf16 v[144:147], v[252:255], v[76:79], v[144:147]
    ds_read_b64_tr_b16 v[48:49], v9 offset:57344
    v_mfma_f32_16x16x32_bf16 v[176:179], v[252:255], v[80:83], v[176:179]
    s_mov_b32 s33, 82944
    buffer_load_dwordx4 v[72:75], v10, s[4:7], s33 offen sc1
    v_mfma_f32_16x16x32_bf16 v[208:211], v[252:255], v[84:87], v[208:211]
    ds_read_b64_tr_b16 v[50:51], v9 offset:59392
    v_mfma_f32_16x16x32_bf16 v[240:243], v[252:255], v[88:91], v[240:243]
    s_waitcnt lgkmcnt(4)
    v_mfma_f32_16x16x32_bf16 v[132:135], v[40:43], v[76:79], v[132:135]
    ds_read_b64_tr_b16 v[52:53], v9 offset:61440
    v_mfma_f32_16x16x32_bf16 v[164:167], v[40:43], v[80:83], v[164:167]
    s_mov_b32 s33, 32768
    buffer_load_dwordx4 a[140:143], v14, s[4:7], s33 offen offset:3072 sc1
    v_mfma_f32_16x16x32_bf16 v[196:199], v[40:43], v[84:87], v[196:199]
    ds_read_b64_tr_b16 v[54:55], v9 offset:63488
    v_mfma_f32_16x16x32_bf16 v[228:231], v[40:43], v[88:91], v[228:231]
    s_waitcnt lgkmcnt(4)
    v_mfma_f32_16x16x32_bf16 v[148:151], v[44:47], v[76:79], v[148:151]
    v_add_u32 v6, 0x10000, v6
    v_add_u32 v7, 0x10000, v7
    v_add_u32 v8, 0x10000, v8
    v_add_u32 v9, 0x10000, v9
    ds_read_b64_tr_b16 v[56:57], v6 offset:0
    v_mfma_f32_16x16x32_bf16 v[180:183], v[44:47], v[80:83], v[180:183]
    s_mov_b32 s33, 36864
    buffer_load_dwordx4 a[144:147], v14, s[4:7], s33 offen offset:0 sc1
    v_mfma_f32_16x16x32_bf16 v[212:215], v[44:47], v[84:87], v[212:215]
    ds_read_b64_tr_b16 v[58:59], v6 offset:2048
    v_mfma_f32_16x16x32_bf16 v[244:247], v[44:47], v[88:91], v[244:247]
    s_waitcnt lgkmcnt(4)
    v_mfma_f32_16x16x32_bf16 v[136:139], v[48:51], v[76:79], v[136:139]
    ds_read_b64_tr_b16 v[252:253], v6 offset:4096
    v_mfma_f32_16x16x32_bf16 v[168:171], v[48:51], v[80:83], v[168:171]
    s_mov_b32 s33, 36864
    buffer_load_dwordx4 a[148:151], v14, s[4:7], s33 offen offset:1024 sc1
    v_mfma_f32_16x16x32_bf16 v[200:203], v[48:51], v[84:87], v[200:203]
    ds_read_b64_tr_b16 v[254:255], v6 offset:6144
    v_mfma_f32_16x16x32_bf16 v[232:235], v[48:51], v[88:91], v[232:235]
    s_waitcnt lgkmcnt(4)
    v_mfma_f32_16x16x32_bf16 v[152:155], v[52:55], v[76:79], v[152:155]
    ds_read_b64_tr_b16 v[40:41], v7 offset:0
    v_mfma_f32_16x16x32_bf16 v[184:187], v[52:55], v[80:83], v[184:187]
    v_mfma_f32_16x16x32_bf16 v[216:219], v[52:55], v[84:87], v[216:219]
    ds_read_b64_tr_b16 v[42:43], v7 offset:2048
    v_mfma_f32_16x16x32_bf16 v[248:251], v[52:55], v[88:91], v[248:251]
    s_waitcnt lgkmcnt(4)
    s_waitcnt vmcnt(18)
    v_mfma_f32_16x16x32_bf16 v[124:127], v[56:59], v[92:95], v[124:127]
    ds_read_b64_tr_b16 v[44:45], v7 offset:4096
    v_mfma_f32_16x16x32_bf16 v[156:159], v[56:59], v[96:99], v[156:159]
    s_mov_b32 s33, 19456
    buffer_load_dwordx4 v[76:79], v10, s[4:7], s33 offen sc1
    v_mfma_f32_16x16x32_bf16 v[188:191], v[56:59], v[100:103], v[188:191]
    ds_read_b64_tr_b16 v[46:47], v7 offset:6144
    v_mfma_f32_16x16x32_bf16 v[220:223], v[56:59], v[104:107], v[220:223]
    s_waitcnt lgkmcnt(4)
    v_mfma_f32_16x16x32_bf16 v[140:143], v[252:255], v[92:95], v[140:143]
    ds_read_b64_tr_b16 v[48:49], v8 offset:0
    v_mfma_f32_16x16x32_bf16 v[172:175], v[252:255], v[96:99], v[172:175]
    s_mov_b32 s33, 40960
    buffer_load_dwordx4 v[80:83], v10, s[4:7], s33 offen sc1
    v_mfma_f32_16x16x32_bf16 v[204:207], v[252:255], v[100:103], v[204:207]
    ds_read_b64_tr_b16 v[50:51], v8 offset:2048
    v_mfma_f32_16x16x32_bf16 v[236:239], v[252:255], v[104:107], v[236:239]
    s_waitcnt lgkmcnt(4)
    v_mfma_f32_16x16x32_bf16 v[128:131], v[40:43], v[92:95], v[128:131]
    ds_read_b64_tr_b16 v[52:53], v8 offset:4096
    v_mfma_f32_16x16x32_bf16 v[160:163], v[40:43], v[96:99], v[160:163]
    s_mov_b32 s33, 62464
    buffer_load_dwordx4 v[84:87], v10, s[4:7], s33 offen sc1
    v_mfma_f32_16x16x32_bf16 v[192:195], v[40:43], v[100:103], v[192:195]
    ds_read_b64_tr_b16 v[54:55], v8 offset:6144
    v_mfma_f32_16x16x32_bf16 v[224:227], v[40:43], v[104:107], v[224:227]
    s_waitcnt lgkmcnt(4)
    v_mfma_f32_16x16x32_bf16 v[144:147], v[44:47], v[92:95], v[144:147]
    ds_read_b64_tr_b16 v[56:57], v9 offset:0
    v_mfma_f32_16x16x32_bf16 v[176:179], v[44:47], v[96:99], v[176:179]
    s_mov_b32 s33, 83968
    buffer_load_dwordx4 v[88:91], v10, s[4:7], s33 offen sc1
    v_mfma_f32_16x16x32_bf16 v[208:211], v[44:47], v[100:103], v[208:211]
    ds_read_b64_tr_b16 v[58:59], v9 offset:2048
    v_mfma_f32_16x16x32_bf16 v[240:243], v[44:47], v[104:107], v[240:243]
    s_waitcnt lgkmcnt(4)
    v_mfma_f32_16x16x32_bf16 v[132:135], v[48:51], v[92:95], v[132:135]
    ds_read_b64_tr_b16 v[252:253], v9 offset:4096
    v_mfma_f32_16x16x32_bf16 v[164:167], v[48:51], v[96:99], v[164:167]
    s_mov_b32 s33, 36864
    buffer_load_dwordx4 a[152:155], v14, s[4:7], s33 offen offset:2048 sc1
    v_mfma_f32_16x16x32_bf16 v[196:199], v[48:51], v[100:103], v[196:199]
    ds_read_b64_tr_b16 v[254:255], v9 offset:6144
    v_mfma_f32_16x16x32_bf16 v[228:231], v[48:51], v[104:107], v[228:231]
    s_waitcnt lgkmcnt(4)
    v_mfma_f32_16x16x32_bf16 v[148:151], v[52:55], v[92:95], v[148:151]
    ds_read_b64_tr_b16 v[40:41], v6 offset:8192
    v_mfma_f32_16x16x32_bf16 v[180:183], v[52:55], v[96:99], v[180:183]
    s_mov_b32 s33, 36864
    buffer_load_dwordx4 a[156:159], v14, s[4:7], s33 offen offset:3072 sc1
    v_mfma_f32_16x16x32_bf16 v[212:215], v[52:55], v[100:103], v[212:215]
    ds_read_b64_tr_b16 v[42:43], v6 offset:10240
    v_mfma_f32_16x16x32_bf16 v[244:247], v[52:55], v[104:107], v[244:247]
    s_waitcnt lgkmcnt(4)
    v_mfma_f32_16x16x32_bf16 v[136:139], v[56:59], v[92:95], v[136:139]
    ds_read_b64_tr_b16 v[44:45], v6 offset:12288
    v_mfma_f32_16x16x32_bf16 v[168:171], v[56:59], v[96:99], v[168:171]
    s_mov_b32 s33, 40960
    buffer_load_dwordx4 a[160:163], v14, s[4:7], s33 offen offset:0 sc1
    v_mfma_f32_16x16x32_bf16 v[200:203], v[56:59], v[100:103], v[200:203]
    ds_read_b64_tr_b16 v[46:47], v6 offset:14336
    v_mfma_f32_16x16x32_bf16 v[232:235], v[56:59], v[104:107], v[232:235]
    s_waitcnt lgkmcnt(4)
    v_mfma_f32_16x16x32_bf16 v[152:155], v[252:255], v[92:95], v[152:155]
    ds_read_b64_tr_b16 v[48:49], v7 offset:8192
    v_mfma_f32_16x16x32_bf16 v[184:187], v[252:255], v[96:99], v[184:187]
    s_mov_b32 s33, 40960
    buffer_load_dwordx4 a[164:167], v14, s[4:7], s33 offen offset:1024 sc1
    v_mfma_f32_16x16x32_bf16 v[216:219], v[252:255], v[100:103], v[216:219]
    ds_read_b64_tr_b16 v[50:51], v7 offset:10240
    v_mfma_f32_16x16x32_bf16 v[248:251], v[252:255], v[104:107], v[248:251]
    s_waitcnt lgkmcnt(4)
    s_waitcnt vmcnt(19)
    v_mfma_f32_16x16x32_bf16 v[124:127], v[40:43], v[108:111], v[124:127]
    ds_read_b64_tr_b16 v[52:53], v7 offset:12288
    v_mfma_f32_16x16x32_bf16 v[156:159], v[40:43], v[112:115], v[156:159]
    s_mov_b32 s33, 8192
    buffer_load_dwordx4 v[92:95], v10, s[4:7], s33 offen sc1
    v_mfma_f32_16x16x32_bf16 v[188:191], v[40:43], v[116:119], v[188:191]
    ds_read_b64_tr_b16 v[54:55], v7 offset:14336
    v_mfma_f32_16x16x32_bf16 v[220:223], v[40:43], v[120:123], v[220:223]
    s_waitcnt lgkmcnt(4)
    v_mfma_f32_16x16x32_bf16 v[140:143], v[44:47], v[108:111], v[140:143]
    ds_read_b64_tr_b16 v[56:57], v8 offset:8192
    v_mfma_f32_16x16x32_bf16 v[172:175], v[44:47], v[112:115], v[172:175]
    s_mov_b32 s33, 29696
    buffer_load_dwordx4 v[96:99], v10, s[4:7], s33 offen sc1
    v_mfma_f32_16x16x32_bf16 v[204:207], v[44:47], v[116:119], v[204:207]
    ds_read_b64_tr_b16 v[58:59], v8 offset:10240
    v_mfma_f32_16x16x32_bf16 v[236:239], v[44:47], v[120:123], v[236:239]
    s_waitcnt lgkmcnt(4)
    v_mfma_f32_16x16x32_bf16 v[128:131], v[48:51], v[108:111], v[128:131]
    ds_read_b64_tr_b16 v[252:253], v8 offset:12288
    v_mfma_f32_16x16x32_bf16 v[160:163], v[48:51], v[112:115], v[160:163]
    s_mov_b32 s33, 51200
    buffer_load_dwordx4 v[100:103], v10, s[4:7], s33 offen sc1
    v_mfma_f32_16x16x32_bf16 v[192:195], v[48:51], v[116:119], v[192:195]
    ds_read_b64_tr_b16 v[254:255], v8 offset:14336
    v_mfma_f32_16x16x32_bf16 v[224:227], v[48:51], v[120:123], v[224:227]
    s_waitcnt lgkmcnt(4)
    v_mfma_f32_16x16x32_bf16 v[144:147], v[52:55], v[108:111], v[144:147]
    ds_read_b64_tr_b16 v[40:41], v9 offset:8192
    v_mfma_f32_16x16x32_bf16 v[176:179], v[52:55], v[112:115], v[176:179]
    s_mov_b32 s33, 72704
    buffer_load_dwordx4 v[104:107], v10, s[4:7], s33 offen sc1
    v_mfma_f32_16x16x32_bf16 v[208:211], v[52:55], v[116:119], v[208:211]
    ds_read_b64_tr_b16 v[42:43], v9 offset:10240
    v_mfma_f32_16x16x32_bf16 v[240:243], v[52:55], v[120:123], v[240:243]
    s_waitcnt lgkmcnt(4)
    v_mfma_f32_16x16x32_bf16 v[132:135], v[56:59], v[108:111], v[132:135]
    ds_read_b64_tr_b16 v[44:45], v9 offset:12288
    v_mfma_f32_16x16x32_bf16 v[164:167], v[56:59], v[112:115], v[164:167]
    s_mov_b32 s33, 40960
    buffer_load_dwordx4 a[168:171], v14, s[4:7], s33 offen offset:2048 sc1
    v_mfma_f32_16x16x32_bf16 v[196:199], v[56:59], v[116:119], v[196:199]
    ds_read_b64_tr_b16 v[46:47], v9 offset:14336
    v_mfma_f32_16x16x32_bf16 v[228:231], v[56:59], v[120:123], v[228:231]
    s_waitcnt lgkmcnt(4)
    v_mfma_f32_16x16x32_bf16 v[148:151], v[252:255], v[108:111], v[148:151]
    ds_read_b64_tr_b16 v[48:49], v6 offset:16384
    v_mfma_f32_16x16x32_bf16 v[180:183], v[252:255], v[112:115], v[180:183]
    s_mov_b32 s33, 40960
    buffer_load_dwordx4 a[172:175], v14, s[4:7], s33 offen offset:3072 sc1
    v_mfma_f32_16x16x32_bf16 v[212:215], v[252:255], v[116:119], v[212:215]
    ds_read_b64_tr_b16 v[50:51], v6 offset:18432
    v_mfma_f32_16x16x32_bf16 v[244:247], v[252:255], v[120:123], v[244:247]
    s_waitcnt lgkmcnt(4)
    v_mfma_f32_16x16x32_bf16 v[136:139], v[40:43], v[108:111], v[136:139]
    ds_read_b64_tr_b16 v[52:53], v6 offset:20480
    v_mfma_f32_16x16x32_bf16 v[168:171], v[40:43], v[112:115], v[168:171]
    s_mov_b32 s33, 45056
    buffer_load_dwordx4 a[176:179], v14, s[4:7], s33 offen offset:0 sc1
    v_mfma_f32_16x16x32_bf16 v[200:203], v[40:43], v[116:119], v[200:203]
    ds_read_b64_tr_b16 v[54:55], v6 offset:22528
    v_mfma_f32_16x16x32_bf16 v[232:235], v[40:43], v[120:123], v[232:235]
    s_waitcnt lgkmcnt(4)
    v_mfma_f32_16x16x32_bf16 v[152:155], v[44:47], v[108:111], v[152:155]
    ds_read_b64_tr_b16 v[56:57], v7 offset:16384
    v_mfma_f32_16x16x32_bf16 v[184:187], v[44:47], v[112:115], v[184:187]
    v_mfma_f32_16x16x32_bf16 v[216:219], v[44:47], v[116:119], v[216:219]
    ds_read_b64_tr_b16 v[58:59], v7 offset:18432
    v_mfma_f32_16x16x32_bf16 v[248:251], v[44:47], v[120:123], v[248:251]
    s_waitcnt lgkmcnt(4)
    s_waitcnt vmcnt(18)
    v_mfma_f32_16x16x32_bf16 v[124:127], v[48:51], v[60:63], v[124:127]
    ds_read_b64_tr_b16 v[252:253], v7 offset:20480
    v_mfma_f32_16x16x32_bf16 v[156:159], v[48:51], v[64:67], v[156:159]
    s_mov_b32 s33, 9216
    buffer_load_dwordx4 v[108:111], v10, s[4:7], s33 offen sc1
    v_mfma_f32_16x16x32_bf16 v[188:191], v[48:51], v[68:71], v[188:191]
    ds_read_b64_tr_b16 v[254:255], v7 offset:22528
    v_mfma_f32_16x16x32_bf16 v[220:223], v[48:51], v[72:75], v[220:223]
    s_waitcnt lgkmcnt(4)
    v_mfma_f32_16x16x32_bf16 v[140:143], v[52:55], v[60:63], v[140:143]
    ds_read_b64_tr_b16 v[40:41], v8 offset:16384
    v_mfma_f32_16x16x32_bf16 v[172:175], v[52:55], v[64:67], v[172:175]
    s_mov_b32 s33, 30720
    buffer_load_dwordx4 v[112:115], v10, s[4:7], s33 offen sc1
    v_mfma_f32_16x16x32_bf16 v[204:207], v[52:55], v[68:71], v[204:207]
    ds_read_b64_tr_b16 v[42:43], v8 offset:18432
    v_mfma_f32_16x16x32_bf16 v[236:239], v[52:55], v[72:75], v[236:239]
    s_waitcnt lgkmcnt(4)
    v_mfma_f32_16x16x32_bf16 v[128:131], v[56:59], v[60:63], v[128:131]
    ds_read_b64_tr_b16 v[44:45], v8 offset:20480
    v_mfma_f32_16x16x32_bf16 v[160:163], v[56:59], v[64:67], v[160:163]
    s_mov_b32 s33, 52224
    buffer_load_dwordx4 v[116:119], v10, s[4:7], s33 offen sc1
    v_mfma_f32_16x16x32_bf16 v[192:195], v[56:59], v[68:71], v[192:195]
    ds_read_b64_tr_b16 v[46:47], v8 offset:22528
    v_mfma_f32_16x16x32_bf16 v[224:227], v[56:59], v[72:75], v[224:227]
    s_waitcnt lgkmcnt(4)
    v_mfma_f32_16x16x32_bf16 v[144:147], v[252:255], v[60:63], v[144:147]
    ds_read_b64_tr_b16 v[48:49], v9 offset:16384
    v_mfma_f32_16x16x32_bf16 v[176:179], v[252:255], v[64:67], v[176:179]
    s_mov_b32 s33, 73728
    buffer_load_dwordx4 v[120:123], v10, s[4:7], s33 offen sc1
    v_mfma_f32_16x16x32_bf16 v[208:211], v[252:255], v[68:71], v[208:211]
    ds_read_b64_tr_b16 v[50:51], v9 offset:18432
    v_mfma_f32_16x16x32_bf16 v[240:243], v[252:255], v[72:75], v[240:243]
    s_waitcnt lgkmcnt(4)
    v_mfma_f32_16x16x32_bf16 v[132:135], v[40:43], v[60:63], v[132:135]
    ds_read_b64_tr_b16 v[52:53], v9 offset:20480
    v_mfma_f32_16x16x32_bf16 v[164:167], v[40:43], v[64:67], v[164:167]
    s_mov_b32 s33, 45056
    buffer_load_dwordx4 a[180:183], v14, s[4:7], s33 offen offset:1024 sc1
    v_mfma_f32_16x16x32_bf16 v[196:199], v[40:43], v[68:71], v[196:199]
    ds_read_b64_tr_b16 v[54:55], v9 offset:22528
    v_mfma_f32_16x16x32_bf16 v[228:231], v[40:43], v[72:75], v[228:231]
    s_waitcnt lgkmcnt(4)
    v_mfma_f32_16x16x32_bf16 v[148:151], v[44:47], v[60:63], v[148:151]
    ds_read_b64_tr_b16 v[56:57], v6 offset:24576
    v_mfma_f32_16x16x32_bf16 v[180:183], v[44:47], v[64:67], v[180:183]
    s_mov_b32 s33, 45056
    buffer_load_dwordx4 a[184:187], v14, s[4:7], s33 offen offset:2048 sc1
    v_mfma_f32_16x16x32_bf16 v[212:215], v[44:47], v[68:71], v[212:215]
    ds_read_b64_tr_b16 v[58:59], v6 offset:26624
    v_mfma_f32_16x16x32_bf16 v[244:247], v[44:47], v[72:75], v[244:247]
    s_waitcnt lgkmcnt(4)
    v_mfma_f32_16x16x32_bf16 v[136:139], v[48:51], v[60:63], v[136:139]
    ds_read_b64_tr_b16 v[252:253], v6 offset:28672
    v_mfma_f32_16x16x32_bf16 v[168:171], v[48:51], v[64:67], v[168:171]
    s_mov_b32 s33, 45056
    buffer_load_dwordx4 a[188:191], v14, s[4:7], s33 offen offset:3072 sc1
    v_mfma_f32_16x16x32_bf16 v[200:203], v[48:51], v[68:71], v[200:203]
    ds_read_b64_tr_b16 v[254:255], v6 offset:30720
    v_mfma_f32_16x16x32_bf16 v[232:235], v[48:51], v[72:75], v[232:235]
    s_waitcnt lgkmcnt(4)
    v_mfma_f32_16x16x32_bf16 v[152:155], v[52:55], v[60:63], v[152:155]
    ds_read_b64_tr_b16 v[40:41], v7 offset:24576
    v_mfma_f32_16x16x32_bf16 v[184:187], v[52:55], v[64:67], v[184:187]
    s_mov_b32 s33, 49152
    buffer_load_dwordx4 a[192:195], v14, s[4:7], s33 offen offset:0 sc1
    v_mfma_f32_16x16x32_bf16 v[216:219], v[52:55], v[68:71], v[216:219]
    ds_read_b64_tr_b16 v[42:43], v7 offset:26624
    v_mfma_f32_16x16x32_bf16 v[248:251], v[52:55], v[72:75], v[248:251]
    s_waitcnt lgkmcnt(4)
    s_waitcnt vmcnt(19)
    v_mfma_f32_16x16x32_bf16 v[124:127], v[56:59], v[76:79], v[124:127]
    ds_read_b64_tr_b16 v[44:45], v7 offset:28672
    v_mfma_f32_16x16x32_bf16 v[156:159], v[56:59], v[80:83], v[156:159]
    s_mov_b32 s33, 49152
    buffer_load_dwordx4 a[196:199], v14, s[4:7], s33 offen offset:1024 sc1
    v_mfma_f32_16x16x32_bf16 v[188:191], v[56:59], v[84:87], v[188:191]
    ds_read_b64_tr_b16 v[46:47], v7 offset:30720
    v_mfma_f32_16x16x32_bf16 v[220:223], v[56:59], v[88:91], v[220:223]
    s_waitcnt lgkmcnt(4)
    v_mfma_f32_16x16x32_bf16 v[140:143], v[252:255], v[76:79], v[140:143]
    ds_read_b64_tr_b16 v[48:49], v8 offset:24576
    v_mfma_f32_16x16x32_bf16 v[172:175], v[252:255], v[80:83], v[172:175]
    s_mov_b32 s33, 49152
    buffer_load_dwordx4 a[200:203], v14, s[4:7], s33 offen offset:2048 sc1
    v_mfma_f32_16x16x32_bf16 v[204:207], v[252:255], v[84:87], v[204:207]
    ds_read_b64_tr_b16 v[50:51], v8 offset:26624
    v_mfma_f32_16x16x32_bf16 v[236:239], v[252:255], v[88:91], v[236:239]
    s_waitcnt lgkmcnt(4)
    v_mfma_f32_16x16x32_bf16 v[128:131], v[40:43], v[76:79], v[128:131]
    ds_read_b64_tr_b16 v[52:53], v8 offset:28672
    v_mfma_f32_16x16x32_bf16 v[160:163], v[40:43], v[80:83], v[160:163]
    s_mov_b32 s33, 49152
    buffer_load_dwordx4 a[204:207], v14, s[4:7], s33 offen offset:3072 sc1
    v_mfma_f32_16x16x32_bf16 v[192:195], v[40:43], v[84:87], v[192:195]
    ds_read_b64_tr_b16 v[54:55], v8 offset:30720
    v_mfma_f32_16x16x32_bf16 v[224:227], v[40:43], v[88:91], v[224:227]
    s_waitcnt lgkmcnt(4)
    v_mfma_f32_16x16x32_bf16 v[144:147], v[44:47], v[76:79], v[144:147]
    ds_read_b64_tr_b16 v[56:57], v9 offset:24576
    v_mfma_f32_16x16x32_bf16 v[176:179], v[44:47], v[80:83], v[176:179]
    s_mov_b32 s33, 53248
    buffer_load_dwordx4 a[208:211], v14, s[4:7], s33 offen offset:0 sc1
    v_mfma_f32_16x16x32_bf16 v[208:211], v[44:47], v[84:87], v[208:211]
    ds_read_b64_tr_b16 v[58:59], v9 offset:26624
    v_mfma_f32_16x16x32_bf16 v[240:243], v[44:47], v[88:91], v[240:243]
    s_waitcnt lgkmcnt(4)
    v_mfma_f32_16x16x32_bf16 v[132:135], v[48:51], v[76:79], v[132:135]
    ds_read_b64_tr_b16 v[252:253], v9 offset:28672
    v_mfma_f32_16x16x32_bf16 v[164:167], v[48:51], v[80:83], v[164:167]
    s_mov_b32 s33, 53248
    buffer_load_dwordx4 a[212:215], v14, s[4:7], s33 offen offset:1024 sc1
    v_mfma_f32_16x16x32_bf16 v[196:199], v[48:51], v[84:87], v[196:199]
    ds_read_b64_tr_b16 v[254:255], v9 offset:30720
    v_mfma_f32_16x16x32_bf16 v[228:231], v[48:51], v[88:91], v[228:231]
    s_waitcnt lgkmcnt(4)
    v_mfma_f32_16x16x32_bf16 v[148:151], v[52:55], v[76:79], v[148:151]
    s_barrier
    v_add_u32 v6, 0xffff0000, v6
    v_add_u32 v7, 0xffff0000, v7
    v_add_u32 v8, 0xffff0000, v8
    v_add_u32 v9, 0xffff0000, v9
    ds_read_b64_tr_b16 v[40:41], v6 offset:0
    v_mfma_f32_16x16x32_bf16 v[180:183], v[52:55], v[80:83], v[180:183]
    v_mfma_f32_16x16x32_bf16 v[212:215], v[52:55], v[84:87], v[212:215]
    ds_read_b64_tr_b16 v[42:43], v6 offset:2048
    v_mfma_f32_16x16x32_bf16 v[244:247], v[52:55], v[88:91], v[244:247]
    s_waitcnt lgkmcnt(4)
    v_mfma_f32_16x16x32_bf16 v[136:139], v[56:59], v[76:79], v[136:139]
    ds_read_b64_tr_b16 v[44:45], v6 offset:4096
    v_mfma_f32_16x16x32_bf16 v[168:171], v[56:59], v[80:83], v[168:171]
    v_mfma_f32_16x16x32_bf16 v[200:203], v[56:59], v[84:87], v[200:203]
    ds_read_b64_tr_b16 v[46:47], v6 offset:6144
    v_mfma_f32_16x16x32_bf16 v[232:235], v[56:59], v[88:91], v[232:235]
    s_waitcnt lgkmcnt(4)
    v_mfma_f32_16x16x32_bf16 v[152:155], v[252:255], v[76:79], v[152:155]
    ds_read_b64_tr_b16 v[48:49], v7 offset:0
    v_mfma_f32_16x16x32_bf16 v[184:187], v[252:255], v[80:83], v[184:187]
    v_mfma_f32_16x16x32_bf16 v[216:219], v[252:255], v[84:87], v[216:219]
    ds_read_b64_tr_b16 v[50:51], v7 offset:2048
    v_mfma_f32_16x16x32_bf16 v[248:251], v[252:255], v[88:91], v[248:251]
    s_waitcnt lgkmcnt(4)
    s_waitcnt vmcnt(16)
    v_mfma_f32_16x16x32_bf16 v[124:127], v[40:43], v[92:95], v[124:127]
    ds_read_b64_tr_b16 v[52:53], v7 offset:4096
    v_mfma_f32_16x16x32_bf16 v[156:159], v[40:43], v[96:99], v[156:159]
    s_mov_b32 s33, 53248
    buffer_load_dwordx4 a[216:219], v14, s[4:7], s33 offen offset:2048 sc1
    v_mfma_f32_16x16x32_bf16 v[188:191], v[40:43], v[100:103], v[188:191]
    ds_read_b64_tr_b16 v[54:55], v7 offset:6144
    v_mfma_f32_16x16x32_bf16 v[220:223], v[40:43], v[104:107], v[220:223]
    s_waitcnt lgkmcnt(4)
    v_mfma_f32_16x16x32_bf16 v[140:143], v[44:47], v[92:95], v[140:143]
    ds_read_b64_tr_b16 v[56:57], v8 offset:0
    v_mfma_f32_16x16x32_bf16 v[172:175], v[44:47], v[96:99], v[172:175]
    s_mov_b32 s33, 53248
    buffer_load_dwordx4 a[220:223], v14, s[4:7], s33 offen offset:3072 sc1
    v_mfma_f32_16x16x32_bf16 v[204:207], v[44:47], v[100:103], v[204:207]
    ds_read_b64_tr_b16 v[58:59], v8 offset:2048
    v_mfma_f32_16x16x32_bf16 v[236:239], v[44:47], v[104:107], v[236:239]
    s_waitcnt lgkmcnt(4)
    v_mfma_f32_16x16x32_bf16 v[128:131], v[48:51], v[92:95], v[128:131]
    ds_read_b64_tr_b16 v[252:253], v8 offset:4096
    v_mfma_f32_16x16x32_bf16 v[160:163], v[48:51], v[96:99], v[160:163]
    s_mov_b32 s33, 57344
    buffer_load_dwordx4 a[224:227], v14, s[4:7], s33 offen offset:0 sc1
    v_mfma_f32_16x16x32_bf16 v[192:195], v[48:51], v[100:103], v[192:195]
    ds_read_b64_tr_b16 v[254:255], v8 offset:6144
    v_mfma_f32_16x16x32_bf16 v[224:227], v[48:51], v[104:107], v[224:227]
    s_waitcnt lgkmcnt(4)
    v_mfma_f32_16x16x32_bf16 v[144:147], v[52:55], v[92:95], v[144:147]
    ds_read_b64_tr_b16 v[40:41], v9 offset:0
    v_mfma_f32_16x16x32_bf16 v[176:179], v[52:55], v[96:99], v[176:179]
    s_mov_b32 s33, 57344
    buffer_load_dwordx4 a[228:231], v14, s[4:7], s33 offen offset:1024 sc1
    v_mfma_f32_16x16x32_bf16 v[208:211], v[52:55], v[100:103], v[208:211]
    ds_read_b64_tr_b16 v[42:43], v9 offset:2048
    v_mfma_f32_16x16x32_bf16 v[240:243], v[52:55], v[104:107], v[240:243]
    s_waitcnt lgkmcnt(4)
    v_mfma_f32_16x16x32_bf16 v[132:135], v[56:59], v[92:95], v[132:135]
    ds_read_b64_tr_b16 v[44:45], v9 offset:4096
    v_mfma_f32_16x16x32_bf16 v[164:167], v[56:59], v[96:99], v[164:167]
    s_mov_b32 s33, 57344
    buffer_load_dwordx4 a[232:235], v14, s[4:7], s33 offen offset:2048 sc1
    v_mfma_f32_16x16x32_bf16 v[196:199], v[56:59], v[100:103], v[196:199]
    ds_read_b64_tr_b16 v[46:47], v9 offset:6144
    v_mfma_f32_16x16x32_bf16 v[228:231], v[56:59], v[104:107], v[228:231]
    s_waitcnt lgkmcnt(4)
    v_mfma_f32_16x16x32_bf16 v[148:151], v[252:255], v[92:95], v[148:151]
    ds_read_b64_tr_b16 v[48:49], v6 offset:8192
    v_mfma_f32_16x16x32_bf16 v[180:183], v[252:255], v[96:99], v[180:183]
    v_mfma_f32_16x16x32_bf16 v[212:215], v[252:255], v[100:103], v[212:215]
    ds_read_b64_tr_b16 v[50:51], v6 offset:10240
    v_mfma_f32_16x16x32_bf16 v[244:247], v[252:255], v[104:107], v[244:247]
    s_waitcnt lgkmcnt(4)
    v_mfma_f32_16x16x32_bf16 v[136:139], v[40:43], v[92:95], v[136:139]
    ds_read_b64_tr_b16 v[52:53], v6 offset:12288
    v_mfma_f32_16x16x32_bf16 v[168:171], v[40:43], v[96:99], v[168:171]
    v_mfma_f32_16x16x32_bf16 v[200:203], v[40:43], v[100:103], v[200:203]
    ds_read_b64_tr_b16 v[54:55], v6 offset:14336
    v_mfma_f32_16x16x32_bf16 v[232:235], v[40:43], v[104:107], v[232:235]
    s_waitcnt lgkmcnt(4)
    v_mfma_f32_16x16x32_bf16 v[152:155], v[44:47], v[92:95], v[152:155]
    ds_read_b64_tr_b16 v[56:57], v7 offset:8192
    v_mfma_f32_16x16x32_bf16 v[184:187], v[44:47], v[96:99], v[184:187]
    v_mfma_f32_16x16x32_bf16 v[216:219], v[44:47], v[100:103], v[216:219]
    ds_read_b64_tr_b16 v[58:59], v7 offset:10240
    v_mfma_f32_16x16x32_bf16 v[248:251], v[44:47], v[104:107], v[248:251]
    s_waitcnt lgkmcnt(4)
    s_waitcnt vmcnt(14)
    v_mfma_f32_16x16x32_bf16 v[124:127], v[48:51], v[108:111], v[124:127]
    ds_read_b64_tr_b16 v[252:253], v7 offset:12288
    v_mfma_f32_16x16x32_bf16 v[156:159], v[48:51], v[112:115], v[156:159]
    s_mov_b32 s33, 57344
    buffer_load_dwordx4 a[236:239], v14, s[4:7], s33 offen offset:3072 sc1
    v_mfma_f32_16x16x32_bf16 v[188:191], v[48:51], v[116:119], v[188:191]
    ds_read_b64_tr_b16 v[254:255], v7 offset:14336
    v_mfma_f32_16x16x32_bf16 v[220:223], v[48:51], v[120:123], v[220:223]
    s_waitcnt lgkmcnt(4)
    v_mfma_f32_16x16x32_bf16 v[140:143], v[52:55], v[108:111], v[140:143]
    ds_read_b64_tr_b16 v[40:41], v8 offset:8192
    v_mfma_f32_16x16x32_bf16 v[172:175], v[52:55], v[112:115], v[172:175]
    s_mov_b32 s33, 61440
    buffer_load_dwordx4 a[240:243], v14, s[4:7], s33 offen offset:0 sc1
    v_mfma_f32_16x16x32_bf16 v[204:207], v[52:55], v[116:119], v[204:207]
    ds_read_b64_tr_b16 v[42:43], v8 offset:10240
    v_mfma_f32_16x16x32_bf16 v[236:239], v[52:55], v[120:123], v[236:239]
    s_waitcnt lgkmcnt(4)
    v_mfma_f32_16x16x32_bf16 v[128:131], v[56:59], v[108:111], v[128:131]
    ds_read_b64_tr_b16 v[44:45], v8 offset:12288
    v_mfma_f32_16x16x32_bf16 v[160:163], v[56:59], v[112:115], v[160:163]
    s_mov_b32 s33, 61440
    buffer_load_dwordx4 a[244:247], v14, s[4:7], s33 offen offset:1024 sc1
    v_mfma_f32_16x16x32_bf16 v[192:195], v[56:59], v[116:119], v[192:195]
    ds_read_b64_tr_b16 v[46:47], v8 offset:14336
    v_mfma_f32_16x16x32_bf16 v[224:227], v[56:59], v[120:123], v[224:227]
    s_waitcnt lgkmcnt(4)
    v_mfma_f32_16x16x32_bf16 v[144:147], v[252:255], v[108:111], v[144:147]
    ds_read_b64_tr_b16 v[48:49], v9 offset:8192
    v_mfma_f32_16x16x32_bf16 v[176:179], v[252:255], v[112:115], v[176:179]
    s_mov_b32 s33, 61440
    buffer_load_dwordx4 a[248:251], v14, s[4:7], s33 offen offset:2048 sc1
    v_mfma_f32_16x16x32_bf16 v[208:211], v[252:255], v[116:119], v[208:211]
    ds_read_b64_tr_b16 v[50:51], v9 offset:10240
    v_mfma_f32_16x16x32_bf16 v[240:243], v[252:255], v[120:123], v[240:243]
    s_waitcnt lgkmcnt(4)
    v_mfma_f32_16x16x32_bf16 v[132:135], v[40:43], v[108:111], v[132:135]
    ds_read_b64_tr_b16 v[52:53], v9 offset:12288
    v_mfma_f32_16x16x32_bf16 v[164:167], v[40:43], v[112:115], v[164:167]
    s_mov_b32 s33, 61440
    buffer_load_dwordx4 a[252:255], v14, s[4:7], s33 offen offset:3072 sc1
    v_mfma_f32_16x16x32_bf16 v[196:199], v[40:43], v[116:119], v[196:199]
    ds_read_b64_tr_b16 v[54:55], v9 offset:14336
    v_mfma_f32_16x16x32_bf16 v[228:231], v[40:43], v[120:123], v[228:231]
    s_waitcnt lgkmcnt(4)
    v_mfma_f32_16x16x32_bf16 v[148:151], v[44:47], v[108:111], v[148:151]
    v_mfma_f32_16x16x32_bf16 v[180:183], v[44:47], v[112:115], v[180:183]
    v_mfma_f32_16x16x32_bf16 v[212:215], v[44:47], v[116:119], v[212:215]
    v_mfma_f32_16x16x32_bf16 v[244:247], v[44:47], v[120:123], v[244:247]
    s_waitcnt lgkmcnt(2)
    v_mfma_f32_16x16x32_bf16 v[136:139], v[48:51], v[108:111], v[136:139]
    v_mfma_f32_16x16x32_bf16 v[168:171], v[48:51], v[112:115], v[168:171]
    v_mfma_f32_16x16x32_bf16 v[200:203], v[48:51], v[116:119], v[200:203]
    v_mfma_f32_16x16x32_bf16 v[232:235], v[48:51], v[120:123], v[232:235]
    s_waitcnt lgkmcnt(0)
    v_mfma_f32_16x16x32_bf16 v[152:155], v[52:55], v[108:111], v[152:155]
    v_mfma_f32_16x16x32_bf16 v[184:187], v[52:55], v[112:115], v[184:187]
    v_mfma_f32_16x16x32_bf16 v[216:219], v[52:55], v[116:119], v[216:219]
    v_mfma_f32_16x16x32_bf16 v[248:251], v[52:55], v[120:123], v[248:251]
    v_pk_mul_f32 v[124:125], v[124:125], v[140:141]
    v_pk_mul_f32 v[126:127], v[126:127], v[142:143]
    v_pk_mul_f32 v[128:129], v[128:129], v[144:145]
    v_pk_mul_f32 v[130:131], v[130:131], v[146:147]
    v_cvt_pk_bf16_f32 v140, v124, v125
    v_cvt_pk_bf16_f32 v141, v126, v127
    v_cvt_pk_bf16_f32 v142, v128, v129
    v_cvt_pk_bf16_f32 v143, v130, v131
    s_mov_b32 s33, 0
    buffer_store_dwordx4 v[140:143], v11, s[4:7], s33 offen offset:0 sc1
    v_pk_mul_f32 v[156:157], v[156:157], v[172:173]
    v_pk_mul_f32 v[158:159], v[158:159], v[174:175]
    v_pk_mul_f32 v[160:161], v[160:161], v[176:177]
    v_pk_mul_f32 v[162:163], v[162:163], v[178:179]
    v_cvt_pk_bf16_f32 v172, v156, v157
    v_cvt_pk_bf16_f32 v173, v158, v159
    v_cvt_pk_bf16_f32 v174, v160, v161
    v_cvt_pk_bf16_f32 v175, v162, v163
    s_mov_b32 s33, 56320
    buffer_store_dwordx4 v[172:175], v11, s[4:7], s33 offen offset:0 sc1
    v_pk_mul_f32 v[188:189], v[188:189], v[204:205]
    v_pk_mul_f32 v[190:191], v[190:191], v[206:207]
    v_pk_mul_f32 v[192:193], v[192:193], v[208:209]
    v_pk_mul_f32 v[194:195], v[194:195], v[210:211]
    v_cvt_pk_bf16_f32 v204, v188, v189
    v_cvt_pk_bf16_f32 v205, v190, v191
    v_cvt_pk_bf16_f32 v206, v192, v193
    v_cvt_pk_bf16_f32 v207, v194, v195
    s_mov_b32 s33, 112640
    buffer_store_dwordx4 v[204:207], v11, s[4:7], s33 offen offset:0 sc1
    v_pk_mul_f32 v[220:221], v[220:221], v[236:237]
    v_pk_mul_f32 v[222:223], v[222:223], v[238:239]
    v_pk_mul_f32 v[224:225], v[224:225], v[240:241]
    v_pk_mul_f32 v[226:227], v[226:227], v[242:243]
    v_cvt_pk_bf16_f32 v236, v220, v221
    v_cvt_pk_bf16_f32 v237, v222, v223
    v_cvt_pk_bf16_f32 v238, v224, v225
    v_cvt_pk_bf16_f32 v239, v226, v227
    s_mov_b32 s33, 168960
    buffer_store_dwordx4 v[236:239], v11, s[4:7], s33 offen offset:0 sc1
    v_pk_mul_f32 v[132:133], v[132:133], v[148:149]
    v_pk_mul_f32 v[134:135], v[134:135], v[150:151]
    v_pk_mul_f32 v[136:137], v[136:137], v[152:153]
    v_pk_mul_f32 v[138:139], v[138:139], v[154:155]
    v_cvt_pk_bf16_f32 v148, v132, v133
    v_cvt_pk_bf16_f32 v149, v134, v135
    v_cvt_pk_bf16_f32 v150, v136, v137
    v_cvt_pk_bf16_f32 v151, v138, v139
    s_mov_b32 s33, 0
    buffer_store_dwordx4 v[148:151], v11, s[4:7], s33 offen offset:1024 sc1
    v_pk_mul_f32 v[164:165], v[164:165], v[180:181]
    v_pk_mul_f32 v[166:167], v[166:167], v[182:183]
    v_pk_mul_f32 v[168:169], v[168:169], v[184:185]
    v_pk_mul_f32 v[170:171], v[170:171], v[186:187]
    v_cvt_pk_bf16_f32 v180, v164, v165
    v_cvt_pk_bf16_f32 v181, v166, v167
    v_cvt_pk_bf16_f32 v182, v168, v169
    v_cvt_pk_bf16_f32 v183, v170, v171
    s_mov_b32 s33, 56320
    buffer_store_dwordx4 v[180:183], v11, s[4:7], s33 offen offset:1024 sc1
    v_pk_mul_f32 v[196:197], v[196:197], v[212:213]
    v_pk_mul_f32 v[198:199], v[198:199], v[214:215]
    v_pk_mul_f32 v[200:201], v[200:201], v[216:217]
    v_pk_mul_f32 v[202:203], v[202:203], v[218:219]
    v_cvt_pk_bf16_f32 v212, v196, v197
    v_cvt_pk_bf16_f32 v213, v198, v199
    v_cvt_pk_bf16_f32 v214, v200, v201
    v_cvt_pk_bf16_f32 v215, v202, v203
    s_mov_b32 s33, 112640
    buffer_store_dwordx4 v[212:215], v11, s[4:7], s33 offen offset:1024 sc1
    v_pk_mul_f32 v[228:229], v[228:229], v[244:245]
    v_pk_mul_f32 v[230:231], v[230:231], v[246:247]
    v_pk_mul_f32 v[232:233], v[232:233], v[248:249]
    v_pk_mul_f32 v[234:235], v[234:235], v[250:251]
    v_cvt_pk_bf16_f32 v244, v228, v229
    v_cvt_pk_bf16_f32 v245, v230, v231
    v_cvt_pk_bf16_f32 v246, v232, v233
    v_cvt_pk_bf16_f32 v247, v234, v235
    s_mov_b32 s33, 168960
    buffer_store_dwordx4 v[244:247], v11, s[4:7], s33 offen offset:1024 sc1
    s_cmp_eq_u32 s30, 3
    s_cbranch_scc1 L_p_91
    s_mov_b32 s33, 65536
    buffer_load_dwordx4 v[16:19], v14, s[4:7], s33 offen offset:0 sc1
    s_add_u32 s33, s42, 65536
    buffer_load_dwordx4 v[20:23], v14, s[4:7], s33 offen offset:1024 sc1
    s_add_u32 s33, s42, 65536
    buffer_load_dwordx4 v[24:27], v14, s[4:7], s33 offen offset:2048 sc1
    s_add_u32 s33, s42, 65536
    buffer_load_dwordx4 v[28:31], v14, s[4:7], s33 offen offset:3072 sc1
    s_add_u32 s33, s42, 69632
    buffer_load_dwordx4 v[32:35], v14, s[4:7], s33 offen offset:0 sc1
    s_add_u32 s33, s42, 69632
    buffer_load_dwordx4 v[36:39], v14, s[4:7], s33 offen offset:1024 sc1
    s_waitcnt vmcnt(6)
    s_branch L_p_92
L_p_91:
    s_waitcnt vmcnt(0)
L_p_92:
    s_barrier
    s_cmp_lg_u32 s30, 3
    s_cbranch_scc1 L_p_93
    s_lshl_b32 s33, s28, 10
    s_add_u32 s33, s33, 0x1780280
    s_lshl_b32 s34, s45, 2
    s_add_u32 s33, s33, s34
    v_mov_b32 v2, s33
    v_mov_b32 v3, s44
    s_mov_b32 exec_lo, 0x1
    s_mov_b32 exec_hi, 0
    s_cmp_lg_u32 s32, 0
    s_cbranch_scc1 L_p_94
    buffer_store_dword v3, v2, s[4:7], 0 offen
    s_branch L_p_95
L_p_94:
    buffer_wbl2 sc1
    s_waitcnt vmcnt(0)
    buffer_store_dword v3, v2, s[4:7], 0 offen sc1
L_p_95:
    s_mov_b64 exec, -1
L_p_93:
    s_branch L_p_86
L_p_87:
    s_mov_b32 s34, 0x900000
    buffer_store_dwordx2 v[16:17], v15, s[4:7], s34 offen offset:0
    s_mov_b32 s34, 0x900000
    buffer_store_dwordx2 v[18:19], v15, s[4:7], s34 offen offset:1024
    s_mov_b32 s34, 0x900000
    buffer_store_dwordx2 v[20:21], v15, s[4:7], s34 offen offset:2048
    s_mov_b32 s34, 0x900000
    buffer_store_dwordx2 v[22:23], v15, s[4:7], s34 offen offset:3072
    s_mov_b32 s34, 0x901000
    buffer_store_dwordx2 v[24:25], v15, s[4:7], s34 offen offset:0
    s_cmp_lg_u32 s30, 3
    s_cbranch_scc1 L_p_96
    s_lshl_b32 s33, s28, 7
    s_add_u32 s33, s33, 0x1784000
    v_lshl_add_u32 v2, v1, 2, s33
    s_mov_b32 exec_lo, 0xffffffff
    s_mov_b32 exec_hi, 0
    s_mov_b32 s3, 1048576
L_p_97:
    buffer_load_dword v3, v2, s[4:7], 0 offen sc1
    s_waitcnt vmcnt(0)
    v_cmp_ne_u32 vcc, s31, v3
    s_cbranch_vccz L_p_98
    s_sub_u32 s3, s3, 1
    s_cmp_lg_u32 s3, 0
    s_cbranch_scc1 L_p_97
    s_mov_b64 exec, -1
    s_branch L_end
L_p_98:
    s_mov_b64 exec, -1
L_p_96:
    s_barrier
    s_mov_b32 s33, 0
    buffer_load_dwordx4 a[0:3], v14, s[4:7], s33 offen offset:0 sc1
    s_mov_b32 s33, 0
    buffer_load_dwordx4 a[4:7], v14, s[4:7], s33 offen offset:1024 sc1
    s_mov_b32 s33, 0
    buffer_load_dwordx4 a[8:11], v14, s[4:7], s33 offen offset:2048 sc1
    s_mov_b32 s33, 0
    buffer_load_dwordx4 a[12:15], v14, s[4:7], s33 offen offset:3072 sc1
    s_mov_b32 s33, 4096
    buffer_load_dwordx4 a[16:19], v14, s[4:7], s33 offen offset:0 sc1
    s_mov_b32 s33, 4096
    buffer_load_dwordx4 a[20:23], v14, s[4:7], s33 offen offset:1024 sc1
    s_mov_b32 s33, 4096
    buffer_load_dwordx4 a[24:27], v14, s[4:7], s33 offen offset:2048 sc1
    s_mov_b32 s33, 4096
    buffer_load_dwordx4 a[28:31], v14, s[4:7], s33 offen offset:3072 sc1
    s_mov_b32 s33, 8192
    buffer_load_dwordx4 a[32:35], v14, s[4:7], s33 offen offset:0 sc1
    s_mov_b32 s33, 8192
    buffer_load_dwordx4 a[36:39], v14, s[4:7], s33 offen offset:1024 sc1
    s_mov_b32 s33, 8192
    buffer_load_dwordx4 a[40:43], v14, s[4:7], s33 offen offset:2048 sc1
    s_mov_b32 s33, 8192
    buffer_load_dwordx4 a[44:47], v14, s[4:7], s33 offen offset:3072 sc1
    s_mov_b32 s33, 12288
    buffer_load_dwordx4 a[48:51], v14, s[4:7], s33 offen offset:0 sc1
    s_mov_b32 s33, 12288
    buffer_load_dwordx4 a[52:55], v14, s[4:7], s33 offen offset:1024 sc1
    s_mov_b32 s33, 12288
    buffer_load_dwordx4 a[56:59], v14, s[4:7], s33 offen offset:2048 sc1
    s_mov_b32 s33, 12288
    buffer_load_dwordx4 a[60:63], v14, s[4:7], s33 offen offset:3072 sc1
    s_mov_b32 s33, 16384
    buffer_load_dwordx4 a[64:67], v14, s[4:7], s33 offen offset:0 sc1
    s_mov_b32 s33, 16384
    buffer_load_dwordx4 a[68:71], v14, s[4:7], s33 offen offset:1024 sc1
    s_mov_b32 s33, 16384
    buffer_load_dwordx4 a[72:75], v14, s[4:7], s33 offen offset:2048 sc1
    s_mov_b32 s33, 16384
    buffer_load_dwordx4 a[76:79], v14, s[4:7], s33 offen offset:3072 sc1
    s_mov_b32 s33, 20480
    buffer_load_dwordx4 a[80:83], v14, s[4:7], s33 offen offset:0 sc1
    s_mov_b32 s33, 20480
    buffer_load_dwordx4 a[84:87], v14, s[4:7], s33 offen offset:1024 sc1
    s_mov_b32 s33, 20480
    buffer_load_dwordx4 a[88:91], v14, s[4:7], s33 offen offset:2048 sc1
    s_mov_b32 s33, 20480
    buffer_load_dwordx4 a[92:95], v14, s[4:7], s33 offen offset:3072 sc1
    s_mov_b32 s33, 24576
    buffer_load_dwordx4 a[96:99], v14, s[4:7], s33 offen offset:0 sc1
    s_mov_b32 s33, 24576
    buffer_load_dwordx4 a[100:103], v14, s[4:7], s33 offen offset:1024 sc1
    s_mov_b32 s33, 24576
    buffer_load_dwordx4 a[104:107], v14, s[4:7], s33 offen offset:2048 sc1
    s_mov_b32 s33, 24576
    buffer_load_dwordx4 a[108:111], v14, s[4:7], s33 offen offset:3072 sc1
    s_mov_b32 s33, 28672
    buffer_load_dwordx4 a[112:115], v14, s[4:7], s33 offen offset:0 sc1
    s_mov_b32 s33, 28672
    buffer_load_dwordx4 a[116:119], v14, s[4:7], s33 offen offset:1024 sc1
    s_mov_b32 s33, 28672
    buffer_load_dwordx4 a[120:123], v14, s[4:7], s33 offen offset:2048 sc1
    s_mov_b32 s33, 28672
    buffer_load_dwordx4 a[124:127], v14, s[4:7], s33 offen offset:3072 sc1
    s_waitcnt vmcnt(0)
    s_mov_b32 s33, 32768
    buffer_load_dwordx4 a[128:131], v14, s[4:7], s33 offen offset:0 sc1
    s_mov_b32 s33, 32768
    buffer_load_dwordx4 a[132:135], v14, s[4:7], s33 offen offset:1024 sc1
    s_mov_b32 s33, 32768
    buffer_load_dwordx4 a[136:139], v14, s[4:7], s33 offen offset:2048 sc1
    s_mov_b32 s33, 32768
    buffer_load_dwordx4 a[140:143], v14, s[4:7], s33 offen offset:3072 sc1
    s_mov_b32 s33, 36864
    buffer_load_dwordx4 a[144:147], v14, s[4:7], s33 offen offset:0 sc1
    s_mov_b32 s33, 36864
    buffer_load_dwordx4 a[148:151], v14, s[4:7], s33 offen offset:1024 sc1
    s_mov_b32 s33, 36864
    buffer_load_dwordx4 a[152:155], v14, s[4:7], s33 offen offset:2048 sc1
    s_mov_b32 s33, 36864
    buffer_load_dwordx4 a[156:159], v14, s[4:7], s33 offen offset:3072 sc1
    s_mov_b32 s33, 40960
    buffer_load_dwordx4 a[160:163], v14, s[4:7], s33 offen offset:0 sc1
    s_mov_b32 s33, 40960
    buffer_load_dwordx4 a[164:167], v14, s[4:7], s33 offen offset:1024 sc1
    s_mov_b32 s33, 40960
    buffer_load_dwordx4 a[168:171], v14, s[4:7], s33 offen offset:2048 sc1
    s_mov_b32 s33, 40960
    buffer_load_dwordx4 a[172:175], v14, s[4:7], s33 offen offset:3072 sc1
    s_mov_b32 s33, 45056
    buffer_load_dwordx4 a[176:179], v14, s[4:7], s33 offen offset:0 sc1
    s_mov_b32 s33, 45056
    buffer_load_dwordx4 a[180:183], v14, s[4:7], s33 offen offset:1024 sc1
    s_mov_b32 s33, 45056
    buffer_load_dwordx4 a[184:187], v14, s[4:7], s33 offen offset:2048 sc1
    s_mov_b32 s33, 45056
    buffer_load_dwordx4 a[188:191], v14, s[4:7], s33 offen offset:3072 sc1
    s_mov_b32 s33, 49152
    buffer_load_dwordx4 a[192:195], v14, s[4:7], s33 offen offset:0 sc1
    s_mov_b32 s33, 49152
    buffer_load_dwordx4 a[196:199], v14, s[4:7], s33 offen offset:1024 sc1
    s_mov_b32 s33, 49152
    buffer_load_dwordx4 a[200:203], v14, s[4:7], s33 offen offset:2048 sc1
    s_mov_b32 s33, 49152
    buffer_load_dwordx4 a[204:207], v14, s[4:7], s33 offen offset:3072 sc1
    s_mov_b32 s33, 53248
    buffer_load_dwordx4 a[208:211], v14, s[4:7], s33 offen offset:0 sc1
    s_mov_b32 s33, 53248
    buffer_load_dwordx4 a[212:215], v14, s[4:7], s33 offen offset:1024 sc1
    s_mov_b32 s33, 53248
    buffer_load_dwordx4 a[216:219], v14, s[4:7], s33 offen offset:2048 sc1
    s_mov_b32 s33, 53248
    buffer_load_dwordx4 a[220:223], v14, s[4:7], s33 offen offset:3072 sc1
    s_mov_b32 s33, 57344
    buffer_load_dwordx4 a[224:227], v14, s[4:7], s33 offen offset:0 sc1
    s_mov_b32 s33, 57344
    buffer_load_dwordx4 a[228:231], v14, s[4:7], s33 offen offset:1024 sc1
    s_mov_b32 s33, 57344
    buffer_load_dwordx4 a[232:235], v14, s[4:7], s33 offen offset:2048 sc1
    s_mov_b32 s33, 57344
    buffer_load_dwordx4 a[236:239], v14, s[4:7], s33 offen offset:3072 sc1
    s_mov_b32 s33, 61440
    buffer_load_dwordx4 a[240:243], v14, s[4:7], s33 offen offset:0 sc1
    s_mov_b32 s33, 61440
    buffer_load_dwordx4 a[244:247], v14, s[4:7], s33 offen offset:1024 sc1
    s_mov_b32 s33, 61440
    buffer_load_dwordx4 a[248:251], v14, s[4:7], s33 offen offset:2048 sc1
    s_mov_b32 s33, 61440
    buffer_load_dwordx4 a[252:255], v14, s[4:7], s33 offen offset:3072 sc1
    s_waitcnt vmcnt(0)
    s_mov_b32 s33, 65536
    buffer_load_dwordx4 v[16:19], v14, s[4:7], s33 offen offset:0 sc1
    s_add_u32 s33, s42, 65536
    buffer_load_dwordx4 v[20:23], v14, s[4:7], s33 offen offset:1024 sc1
    s_add_u32 s33, s42, 65536
    buffer_load_dwordx4 v[24:27], v14, s[4:7], s33 offen offset:2048 sc1
    s_add_u32 s33, s42, 65536
    buffer_load_dwordx4 v[28:31], v14, s[4:7], s33 offen offset:3072 sc1
    s_add_u32 s33, s42, 69632
    buffer_load_dwordx4 v[32:35], v14, s[4:7], s33 offen offset:0 sc1
    s_add_u32 s33, s42, 69632
    buffer_load_dwordx4 v[36:39], v14, s[4:7], s33 offen offset:1024 sc1
    s_waitcnt vmcnt(0) lgkmcnt(0)
    s_barrier
    s_cmp_lg_u32 s30, 3
    s_cbranch_scc1 L_p_99
    s_lshl_b32 s33, s28, 10
    s_add_u32 s33, s33, 0x1780280
    s_lshl_b32 s34, s45, 2
    s_add_u32 s33, s33, s34
    v_mov_b32 v2, s33
    v_mov_b32 v3, s44
    s_mov_b32 exec_lo, 0x1
    s_mov_b32 exec_hi, 0
    s_cmp_lg_u32 s32, 0
    s_cbranch_scc1 L_p_100
    buffer_store_dword v3, v2, s[4:7], 0 offen
    s_branch L_p_101
L_p_100:
    buffer_wbl2 sc1
    s_waitcnt vmcnt(0)
    buffer_store_dword v3, v2, s[4:7], 0 offen sc1
L_p_101:
    s_mov_b64 exec, -1
L_p_99:
L_p_86:
    s_lshl_b32 s33, s28, 4
    s_and_b32 s34, s29, 3
    s_lshl_b32 s34, s34, 2
    s_add_u32 s49, s33, s34
    s_lshl_b32 s33, s43, 10
    s_add_u32 s33, s33, 0xc00000
    v_lshl_add_u32 v6, v1, 4, s33
    v_and_b32 v9, 15, v1
    s_add_u32 s33, s49, s30
    s_lshl_b32 s33, s33, 4
    v_add_u32 v9, s33, v9
    v_mul_u32_u24 v9, 1280, v9
    s_lshr_b32 s33, s29, 2
    s_mul_i32 s34, s33, 160
    v_add_u32 v9, s34, v9
    v_lshrrev_b32 v11, 4, v1
    v_lshl_add_u32 v10, v11, 3, v9
    v_lshl_add_u32 v9, v11, 4, v9
    s_lshl_b32 s34, s34, 1
    s_add_u32 s34, s34, 0x1603200
    v_lshl_add_u32 v12, v11, 4, s34
    v_lshl_add_u32 v11, v11, 5, s34
    v_lshlrev_b32 v13, 4, v1
    s_mul_i32 s33, s30, 15360
    v_add_u32 v15, s33, v13
    s_mul_i32 s33, s30, 2816
    s_add_u32 s33, s33, 65536
    v_and_b32 v4, 15, v1
    v_lshrrev_b32 v5, 4, v1
    v_mul_u32_u24 v4, 176, v4
    v_add_u32 v4, s33, v4
    v_lshl_add_u32 v246, v5, 4, v4
    v_lshl_add_u32 v247, v5, 3, v4
    s_add_u32 s34, s49, s30
    s_mul_i32 s34, s34, 20480
    s_lshr_b32 s66, s29, 2
    s_mul_i32 s66, s66, 160
    s_add_u32 s34, s34, s66
    v_add_u32 v4, 0, v1
    v_mul_u32_u24 v5, 205, v4
    v_lshrrev_b32 v5, 11, v5
    v_mul_u32_u24 v248, 10, v5
    v_sub_u32 v4, v4, v248
    v_lshlrev_b32 v4, 4, v4
    v_mul_u32_u24 v248, 176, v5
    v_add3_u32 v248, v248, v4, s33
    v_mul_u32_u24 v5, 1280, v5
    v_add3_u32 v251, v5, v4, s34
    v_add_u32 v4, 64, v1
    v_mul_u32_u24 v5, 205, v4
    v_lshrrev_b32 v5, 11, v5
    v_mul_u32_u24 v249, 10, v5
    v_sub_u32 v4, v4, v249
    v_lshlrev_b32 v4, 4, v4
    v_mul_u32_u24 v249, 176, v5
    v_add3_u32 v249, v249, v4, s33
    v_mul_u32_u24 v5, 1280, v5
    v_add3_u32 v252, v5, v4, s34
    v_add_u32 v4, 128, v1
    v_mul_u32_u24 v5, 205, v4
    v_lshrrev_b32 v5, 11, v5
    v_mul_u32_u24 v250, 10, v5
    v_sub_u32 v4, v4, v250
    v_lshlrev_b32 v4, 4, v4
    v_mul_u32_u24 v250, 176, v5
    v_add3_u32 v250, v250, v4, s33
    v_mul_u32_u24 v5, 1280, v5
    v_add3_u32 v253, v5, v4, s34
    v_cmp_gt_u32 vcc, 32, v1
    v_bfrev_b32 v4, 2
    s_nop 0
    v_cndmask_b32 v253, v4, v253, vcc
    v_cndmask_b32 v250, v248, v250, vcc
    s_cmp_lg_u32 s30, 3
    s_cbranch_scc1 L_p_102
    s_lshl_b32 s33, s28, 10
    s_add_u32 s33, s33, 0x1780280
    v_lshl_add_u32 v2, v1, 2, s33
    s_mov_b32 exec_lo, 0xffffffff
    s_mov_b32 exec_hi, 0
    s_mov_b32 s3, 1048576
L_p_103:
    buffer_load_dword v3, v2, s[4:7], 0 offen sc1
    s_waitcnt vmcnt(0)
    v_cmp_ne_u32 vcc, s44, v3
    s_cbranch_vccz L_p_104
    s_sub_u32 s3, s3, 1
    s_cmp_lg_u32 s3, 0
    s_cbranch_scc1 L_p_103
    s_mov_b64 exec, -1
    s_branch L_end
L_p_104:
    s_mov_b64 exec, -1
    s_cmp_ge_u32 s45, 27
    s_cbranch_scc1 L_p_105
    s_mov_b32 s33, 65536
    buffer_load_dwordx4 v[16:19], v14, s[4:7], s33 offen offset:0 sc1
    s_add_u32 s33, s42, 65536
    buffer_load_dwordx4 v[20:23], v14, s[4:7], s33 offen offset:1024 sc1
    s_add_u32 s33, s42, 65536
    buffer_load_dwordx4 v[24:27], v14, s[4:7], s33 offen offset:2048 sc1
    s_add_u32 s33, s42, 65536
    buffer_load_dwordx4 v[28:31], v14, s[4:7], s33 offen offset:3072 sc1
    s_add_u32 s33, s42, 69632
    buffer_load_dwordx4 v[32:35], v14, s[4:7], s33 offen offset:0 sc1
    s_add_u32 s33, s42, 69632
    buffer_load_dwordx4 v[36:39], v14, s[4:7], s33 offen offset:1024 sc1
L_p_105:
L_p_102:
    s_barrier
    s_add_u32 s33, s49, s30
    s_mul_i32 s33, s33, 160
    s_lshr_b32 s34, s29, 2
    s_mul_i32 s34, s34, 20
    s_add_u32 s33, s33, s34
    s_lshl_b32 s33, s33, 7
    v_and_b32 v4, 15, v1
    v_lshrrev_b32 v5, 4, v1
    v_lshl_add_u32 v3, v4, 3, s33
    v_lshl_add_u32 v2, v5, 8, v3
    v_lshl_add_u32 v3, v5, 7, v3
    s_add_u32 s66, s30, 1
    s_and_b32 s66, s66, 3
    s_add_u32 s67, s66, s49
    s_mul_i32 s67, s67, 56320
    s_add_u32 s68, s67, s42
    s_add_u32 s33, s67, 0
    buffer_load_dwordx4 v[80:83], v6, s[4:7], s33 offen offset:0 sc1
    s_add_u32 s33, s67, 0
    buffer_load_dwordx4 v[84:87], v6, s[4:7], s33 offen offset:1024 sc1
    s_add_u32 s33, s67, 0
    buffer_load_dwordx4 v[88:91], v6, s[4:7], s33 offen offset:2048 sc1
    s_add_u32 s33, s67, 0
    buffer_load_dwordx4 v[92:95], v6, s[4:7], s33 offen offset:3072 sc1
    s_add_u32 s33, s67, 4096
    buffer_load_dwordx4 v[96:99], v6, s[4:7], s33 offen offset:0 sc1
    s_add_u32 s33, s67, 4096
    buffer_load_dwordx4 v[100:103], v6, s[4:7], s33 offen offset:1024 sc1
    s_add_u32 s33, s67, 4096
    buffer_load_dwordx4 v[104:107], v6, s[4:7], s33 offen offset:2048 sc1
    s_add_u32 s33, s67, 4096
    buffer_load_dwordx4 v[108:111], v6, s[4:7], s33 offen offset:3072 sc1
    s_add_u32 s33, s67, 8192
    buffer_load_dwordx4 v[112:115], v6, s[4:7], s33 offen offset:0 sc1
    s_add_u32 s33, s67, 8192
    buffer_load_dwordx4 v[116:119], v6, s[4:7], s33 offen offset:1024 sc1
    s_add_u32 s33, s67, 8192
    buffer_load_dwordx4 v[120:123], v6, s[4:7], s33 offen offset:2048 sc1
    s_add_u32 s33, s67, 8192
    buffer_load_dwordx4 v[124:127], v6, s[4:7], s33 offen offset:3072 sc1
    s_add_u32 s33, s67, 12288
    buffer_load_dwordx4 v[128:131], v6, s[4:7], s33 offen offset:0 sc1
    s_add_u32 s33, s68, 12288
    buffer_load_dwordx4 v[132:135], v6, s[4:7], s33 offen offset:1024 sc1
    s_add_u32 s34, s30, 1
    s_and_b32 s34, s34, 3
    s_mul_i32 s34, s34, 15360
    s_add_u32 s34, s34, 0
    v_add_u32 v7, s34, v13
    s_add_u32 s66, s30, 2
    s_and_b32 s66, s66, 3
    s_add_u32 s67, s66, s49
    s_mul_i32 s67, s67, 56320
    s_add_u32 s68, s67, s42
    s_waitcnt vmcnt(13)
    v_mfma_f32_16x16x32_bf16 v[40:43], a[0:3], v[80:83], 0
    v_mfma_f32_16x16x32_bf16 v[44:47], a[4:7], v[80:83], 0
    v_mfma_f32_16x16x32_bf16 v[48:51], a[8:11], v[80:83], 0
    v_mfma_f32_16x16x32_bf16 v[52:55], a[12:15], v[80:83], 0
    v_mfma_f32_16x16x32_bf16 v[56:59], a[16:19], v[80:83], 0
    s_add_u32 s33, s67, 0
    buffer_load_dwordx4 v[80:83], v6, s[4:7], s33 offen offset:0 sc1
    s_waitcnt vmcnt(13)
    v_mfma_f32_16x16x32_bf16 v[40:43], a[20:23], v[84:87], v[40:43]
    v_mfma_f32_16x16x32_bf16 v[44:47], a[24:27], v[84:87], v[44:47]
    v_mfma_f32_16x16x32_bf16 v[48:51], a[28:31], v[84:87], v[48:51]
    v_mfma_f32_16x16x32_bf16 v[52:55], a[32:35], v[84:87], v[52:55]
    v_mfma_f32_16x16x32_bf16 v[56:59], a[36:39], v[84:87], v[56:59]
    s_add_u32 s33, s67, 0
    buffer_load_dwordx4 v[84:87], v6, s[4:7], s33 offen offset:1024 sc1
    s_waitcnt vmcnt(13)
    v_mfma_f32_16x16x32_bf16 v[40:43], a[40:43], v[88:91], v[40:43]
    v_mfma_f32_16x16x32_bf16 v[44:47], a[44:47], v[88:91], v[44:47]
    v_mfma_f32_16x16x32_bf16 v[48:51], a[48:51], v[88:91], v[48:51]
    v_mfma_f32_16x16x32_bf16 v[52:55], a[52:55], v[88:91], v[52:55]
    v_mfma_f32_16x16x32_bf16 v[56:59], a[56:59], v[88:91], v[56:59]
    s_add_u32 s33, s67, 0
    buffer_load_dwordx4 v[88:91], v6, s[4:7], s33 offen offset:2048 sc1
    s_waitcnt vmcnt(13)
    v_mfma_f32_16x16x32_bf16 v[40:43], a[60:63], v[92:95], v[40:43]
    v_mfma_f32_16x16x32_bf16 v[44:47], a[64:67], v[92:95], v[44:47]
    v_mfma_f32_16x16x32_bf16 v[48:51], a[68:71], v[92:95], v[48:51]
    v_mfma_f32_16x16x32_bf16 v[52:55], a[72:75], v[92:95], v[52:55]
    v_mfma_f32_16x16x32_bf16 v[56:59], a[76:79], v[92:95], v[56:59]
    s_add_u32 s33, s67, 0
    buffer_load_dwordx4 v[92:95], v6, s[4:7], s33 offen offset:3072 sc1
    s_waitcnt vmcnt(13)
    v_mfma_f32_16x16x32_bf16 v[40:43], a[80:83], v[96:99], v[40:43]
    v_mfma_f32_16x16x32_bf16 v[44:47], a[84:87], v[96:99], v[44:47]
    v_mfma_f32_16x16x32_bf16 v[48:51], a[88:91], v[96:99], v[48:51]
    v_mfma_f32_16x16x32_bf16 v[52:55], a[92:95], v[96:99], v[52:55]
    v_mfma_f32_16x16x32_bf16 v[56:59], a[96:99], v[96:99], v[56:59]
    s_add_u32 s33, s67, 4096
    buffer_load_dwordx4 v[96:99], v6, s[4:7], s33 offen offset:0 sc1
    s_waitcnt vmcnt(13)
    v_mfma_f32_16x16x32_bf16 v[40:43], a[100:103], v[100:103], v[40:43]
    v_mfma_f32_16x16x32_bf16 v[44:47], a[104:107], v[100:103], v[44:47]
    v_mfma_f32_16x16x32_bf16 v[48:51], a[108:111], v[100:103], v[48:51]
    v_mfma_f32_16x16x32_bf16 v[52:55], a[112:115], v[100:103], v[52:55]
    v_mfma_f32_16x16x32_bf16 v[56:59], a[116:119], v[100:103], v[56:59]
    s_add_u32 s33, s67, 4096
    buffer_load_dwordx4 v[100:103], v6, s[4:7], s33 offen offset:1024 sc1
    s_waitcnt vmcnt(13)
    v_mfma_f32_16x16x32_bf16 v[40:43], a[120:123], v[104:107], v[40:43]
    v_mfma_f32_16x16x32_bf16 v[44:47], a[124:127], v[104:107], v[44:47]
    v_mfma_f32_16x16x32_bf16 v[48:51], a[128:131], v[104:107], v[48:51]
    v_mfma_f32_16x16x32_bf16 v[52:55], a[132:135], v[104:107], v[52:55]
    v_mfma_f32_16x16x32_bf16 v[56:59], a[136:139], v[104:107], v[56:59]
    s_add_u32 s33, s67, 4096
    buffer_load_dwordx4 v[104:107], v6, s[4:7], s33 offen offset:2048 sc1
    s_waitcnt vmcnt(13)
    v_mfma_f32_16x16x32_bf16 v[40:43], a[140:143], v[108:111], v[40:43]
    v_mfma_f32_16x16x32_bf16 v[44:47], a[144:147], v[108:111], v[44:47]
    v_mfma_f32_16x16x32_bf16 v[48:51], a[148:151], v[108:111], v[48:51]
    v_mfma_f32_16x16x32_bf16 v[52:55], a[152:155], v[108:111], v[52:55]
    v_mfma_f32_16x16x32_bf16 v[56:59], a[156:159], v[108:111], v[56:59]
    s_add_u32 s33, s67, 4096
    buffer_load_dwordx4 v[108:111], v6, s[4:7], s33 offen offset:3072 sc1
    s_waitcnt vmcnt(13)
    v_mfma_f32_16x16x32_bf16 v[40:43], a[160:163], v[112:115], v[40:43]
    v_mfma_f32_16x16x32_bf16 v[44:47], a[164:167], v[112:115], v[44:47]
    v_mfma_f32_16x16x32_bf16 v[48:51], a[168:171], v[112:115], v[48:51]
    v_mfma_f32_16x16x32_bf16 v[52:55], a[172:175], v[112:115], v[52:55]
    v_mfma_f32_16x16x32_bf16 v[56:59], a[176:179], v[112:115], v[56:59]
    s_add_u32 s33, s67, 8192
    buffer_load_dwordx4 v[112:115], v6, s[4:7], s33 offen offset:0 sc1
    s_waitcnt vmcnt(13)
    v_mfma_f32_16x16x32_bf16 v[40:43], a[180:183], v[116:119], v[40:43]
    v_mfma_f32_16x16x32_bf16 v[44:47], a[184:187], v[116:119], v[44:47]
    v_mfma_f32_16x16x32_bf16 v[48:51], a[188:191], v[116:119], v[48:51]
    v_mfma_f32_16x16x32_bf16 v[52:55], a[192:195], v[116:119], v[52:55]
    v_mfma_f32_16x16x32_bf16 v[56:59], a[196:199], v[116:119], v[56:59]
    s_add_u32 s33, s67, 8192
    buffer_load_dwordx4 v[116:119], v6, s[4:7], s33 offen offset:1024 sc1
    s_waitcnt vmcnt(13)
    v_mfma_f32_16x16x32_bf16 v[40:43], a[200:203], v[120:123], v[40:43]
    v_mfma_f32_16x16x32_bf16 v[44:47], a[204:207], v[120:123], v[44:47]
    v_mfma_f32_16x16x32_bf16 v[48:51], a[208:211], v[120:123], v[48:51]
    v_mfma_f32_16x16x32_bf16 v[52:55], a[212:215], v[120:123], v[52:55]
    v_mfma_f32_16x16x32_bf16 v[56:59], a[216:219], v[120:123], v[56:59]
    s_add_u32 s33, s67, 8192
    buffer_load_dwordx4 v[120:123], v6, s[4:7], s33 offen offset:2048 sc1
    s_waitcnt vmcnt(13)
    v_mfma_f32_16x16x32_bf16 v[40:43], a[220:223], v[124:127], v[40:43]
    v_mfma_f32_16x16x32_bf16 v[44:47], a[224:227], v[124:127], v[44:47]
    v_mfma_f32_16x16x32_bf16 v[48:51], a[228:231], v[124:127], v[48:51]
    v_mfma_f32_16x16x32_bf16 v[52:55], a[232:235], v[124:127], v[52:55]
    v_mfma_f32_16x16x32_bf16 v[56:59], a[236:239], v[124:127], v[56:59]
    s_add_u32 s33, s67, 8192
    buffer_load_dwordx4 v[124:127], v6, s[4:7], s33 offen offset:3072 sc1
    s_waitcnt vmcnt(13)
    v_mfma_f32_16x16x32_bf16 v[40:43], a[240:243], v[128:131], v[40:43]
    v_mfma_f32_16x16x32_bf16 v[44:47], a[244:247], v[128:131], v[44:47]
    v_mfma_f32_16x16x32_bf16 v[48:51], a[248:251], v[128:131], v[48:51]
    v_mfma_f32_16x16x32_bf16 v[52:55], a[252:255], v[128:131], v[52:55]
    v_mfma_f32_16x16x32_bf16 v[56:59], v[16:19], v[128:131], v[56:59]
    s_add_u32 s33, s67, 12288
    buffer_load_dwordx4 v[128:131], v6, s[4:7], s33 offen offset:0 sc1
    s_waitcnt vmcnt(13)
    v_mfma_f32_16x16x32_bf16 v[40:43], v[20:23], v[132:135], v[40:43]
    v_mfma_f32_16x16x32_bf16 v[44:47], v[24:27], v[132:135], v[44:47]
    v_mfma_f32_16x16x32_bf16 v[48:51], v[28:31], v[132:135], v[48:51]
    v_mfma_f32_16x16x32_bf16 v[52:55], v[32:35], v[132:135], v[52:55]
    v_mfma_f32_16x16x32_bf16 v[56:59], v[36:39], v[132:135], v[56:59]
    s_add_u32 s33, s68, 12288
    buffer_load_dwordx4 v[132:135], v6, s[4:7], s33 offen offset:1024 sc1
    s_add_u32 s34, s30, 2
    s_and_b32 s34, s34, 3
    s_mul_i32 s34, s34, 15360
    s_add_u32 s34, s34, 5120
    v_add_u32 v8, s34, v13
    s_add_u32 s66, s30, 3
    s_and_b32 s66, s66, 3
    s_add_u32 s67, s66, s49
    s_mul_i32 s67, s67, 56320
    s_add_u32 s68, s67, s42
    s_waitcnt vmcnt(13)
    v_mfma_f32_16x16x32_bf16 v[60:63], a[0:3], v[80:83], 0
    v_mfma_f32_16x16x32_bf16 v[64:67], a[4:7], v[80:83], 0
    v_mfma_f32_16x16x32_bf16 v[68:71], a[8:11], v[80:83], 0
    v_mfma_f32_16x16x32_bf16 v[72:75], a[12:15], v[80:83], 0
    v_mfma_f32_16x16x32_bf16 v[76:79], a[16:19], v[80:83], 0
    s_add_u32 s33, s67, 0
    buffer_load_dwordx4 v[80:83], v6, s[4:7], s33 offen offset:0 sc1
    s_waitcnt vmcnt(13)
    v_mfma_f32_16x16x32_bf16 v[60:63], a[20:23], v[84:87], v[60:63]
    v_mfma_f32_16x16x32_bf16 v[64:67], a[24:27], v[84:87], v[64:67]
    v_mfma_f32_16x16x32_bf16 v[68:71], a[28:31], v[84:87], v[68:71]
    v_mfma_f32_16x16x32_bf16 v[72:75], a[32:35], v[84:87], v[72:75]
    v_mfma_f32_16x16x32_bf16 v[76:79], a[36:39], v[84:87], v[76:79]
    s_add_u32 s33, s67, 0
    buffer_load_dwordx4 v[84:87], v6, s[4:7], s33 offen offset:1024 sc1
    s_waitcnt vmcnt(13)
    v_mfma_f32_16x16x32_bf16 v[60:63], a[40:43], v[88:91], v[60:63]
    ds_write_b128 v7, v[40:43] offset:0
    v_mfma_f32_16x16x32_bf16 v[64:67], a[44:47], v[88:91], v[64:67]
    ds_write_b128 v7, v[44:47] offset:1024
    v_mfma_f32_16x16x32_bf16 v[68:71], a[48:51], v[88:91], v[68:71]
    ds_write_b128 v7, v[48:51] offset:2048
    v_mfma_f32_16x16x32_bf16 v[72:75], a[52:55], v[88:91], v[72:75]
    ds_write_b128 v7, v[52:55] offset:3072
    v_mfma_f32_16x16x32_bf16 v[76:79], a[56:59], v[88:91], v[76:79]
    ds_write_b128 v7, v[56:59] offset:4096
    s_add_u32 s33, s67, 0
    buffer_load_dwordx4 v[88:91], v6, s[4:7], s33 offen offset:2048 sc1
    s_waitcnt vmcnt(13)
    v_mfma_f32_16x16x32_bf16 v[60:63], a[60:63], v[92:95], v[60:63]
    v_mfma_f32_16x16x32_bf16 v[64:67], a[64:67], v[92:95], v[64:67]
    v_mfma_f32_16x16x32_bf16 v[68:71], a[68:71], v[92:95], v[68:71]
    v_mfma_f32_16x16x32_bf16 v[72:75], a[72:75], v[92:95], v[72:75]
    v_mfma_f32_16x16x32_bf16 v[76:79], a[76:79], v[92:95], v[76:79]
    s_add_u32 s33, s67, 0
    buffer_load_dwordx4 v[92:95], v6, s[4:7], s33 offen offset:3072 sc1
    s_waitcnt vmcnt(13)
    v_mfma_f32_16x16x32_bf16 v[60:63], a[80:83], v[96:99], v[60:63]
    v_mfma_f32_16x16x32_bf16 v[64:67], a[84:87], v[96:99], v[64:67]
    v_mfma_f32_16x16x32_bf16 v[68:71], a[88:91], v[96:99], v[68:71]
    v_mfma_f32_16x16x32_bf16 v[72:75], a[92:95], v[96:99], v[72:75]
    v_mfma_f32_16x16x32_bf16 v[76:79], a[96:99], v[96:99], v[76:79]
    s_add_u32 s33, s67, 4096
    buffer_load_dwordx4 v[96:99], v6, s[4:7], s33 offen offset:0 sc1
    s_waitcnt vmcnt(13)
    v_mfma_f32_16x16x32_bf16 v[60:63], a[100:103], v[100:103], v[60:63]
    v_mfma_f32_16x16x32_bf16 v[64:67], a[104:107], v[100:103], v[64:67]
    v_mfma_f32_16x16x32_bf16 v[68:71], a[108:111], v[100:103], v[68:71]
    v_mfma_f32_16x16x32_bf16 v[72:75], a[112:115], v[100:103], v[72:75]
    v_mfma_f32_16x16x32_bf16 v[76:79], a[116:119], v[100:103], v[76:79]
    s_add_u32 s33, s67, 4096
    buffer_load_dwordx4 v[100:103], v6, s[4:7], s33 offen offset:1024 sc1
    s_waitcnt vmcnt(13)
    v_mfma_f32_16x16x32_bf16 v[60:63], a[120:123], v[104:107], v[60:63]
    v_mfma_f32_16x16x32_bf16 v[64:67], a[124:127], v[104:107], v[64:67]
    v_mfma_f32_16x16x32_bf16 v[68:71], a[128:131], v[104:107], v[68:71]
    v_mfma_f32_16x16x32_bf16 v[72:75], a[132:135], v[104:107], v[72:75]
    v_mfma_f32_16x16x32_bf16 v[76:79], a[136:139], v[104:107], v[76:79]
    s_add_u32 s33, s67, 4096
    buffer_load_dwordx4 v[104:107], v6, s[4:7], s33 offen offset:2048 sc1
    s_waitcnt vmcnt(13)
    v_mfma_f32_16x16x32_bf16 v[60:63], a[140:143], v[108:111], v[60:63]
    v_mfma_f32_16x16x32_bf16 v[64:67], a[144:147], v[108:111], v[64:67]
    v_mfma_f32_16x16x32_bf16 v[68:71], a[148:151], v[108:111], v[68:71]
    v_mfma_f32_16x16x32_bf16 v[72:75], a[152:155], v[108:111], v[72:75]
    v_mfma_f32_16x16x32_bf16 v[76:79], a[156:159], v[108:111], v[76:79]
    s_add_u32 s33, s67, 4096
    buffer_load_dwordx4 v[108:111], v6, s[4:7], s33 offen offset:3072 sc1
    s_waitcnt vmcnt(13)
    v_mfma_f32_16x16x32_bf16 v[60:63], a[160:163], v[112:115], v[60:63]
    v_mfma_f32_16x16x32_bf16 v[64:67], a[164:167], v[112:115], v[64:67]
    v_mfma_f32_16x16x32_bf16 v[68:71], a[168:171], v[112:115], v[68:71]
    v_mfma_f32_16x16x32_bf16 v[72:75], a[172:175], v[112:115], v[72:75]
    v_mfma_f32_16x16x32_bf16 v[76:79], a[176:179], v[112:115], v[76:79]
    s_add_u32 s33, s67, 8192
    buffer_load_dwordx4 v[112:115], v6, s[4:7], s33 offen offset:0 sc1
    s_waitcnt vmcnt(13)
    v_mfma_f32_16x16x32_bf16 v[60:63], a[180:183], v[116:119], v[60:63]
    v_mfma_f32_16x16x32_bf16 v[64:67], a[184:187], v[116:119], v[64:67]
    v_mfma_f32_16x16x32_bf16 v[68:71], a[188:191], v[116:119], v[68:71]
    v_mfma_f32_16x16x32_bf16 v[72:75], a[192:195], v[116:119], v[72:75]
    v_mfma_f32_16x16x32_bf16 v[76:79], a[196:199], v[116:119], v[76:79]
    s_add_u32 s33, s67, 8192
    buffer_load_dwordx4 v[116:119], v6, s[4:7], s33 offen offset:1024 sc1
    s_waitcnt vmcnt(13)
    v_mfma_f32_16x16x32_bf16 v[60:63], a[200:203], v[120:123], v[60:63]
    v_mfma_f32_16x16x32_bf16 v[64:67], a[204:207], v[120:123], v[64:67]
    v_mfma_f32_16x16x32_bf16 v[68:71], a[208:211], v[120:123], v[68:71]
    v_mfma_f32_16x16x32_bf16 v[72:75], a[212:215], v[120:123], v[72:75]
    v_mfma_f32_16x16x32_bf16 v[76:79], a[216:219], v[120:123], v[76:79]
    s_add_u32 s33, s67, 8192
    buffer_load_dwordx4 v[120:123], v6, s[4:7], s33 offen offset:2048 sc1
    s_waitcnt vmcnt(13)
    v_mfma_f32_16x16x32_bf16 v[60:63], a[220:223], v[124:127], v[60:63]
    v_mfma_f32_16x16x32_bf16 v[64:67], a[224:227], v[124:127], v[64:67]
    v_mfma_f32_16x16x32_bf16 v[68:71], a[228:231], v[124:127], v[68:71]
    v_mfma_f32_16x16x32_bf16 v[72:75], a[232:235], v[124:127], v[72:75]
    v_mfma_f32_16x16x32_bf16 v[76:79], a[236:239], v[124:127], v[76:79]
    s_add_u32 s33, s67, 8192
    buffer_load_dwordx4 v[124:127], v6, s[4:7], s33 offen offset:3072 sc1
    s_waitcnt vmcnt(13)
    v_mfma_f32_16x16x32_bf16 v[60:63], a[240:243], v[128:131], v[60:63]
    v_mfma_f32_16x16x32_bf16 v[64:67], a[244:247], v[128:131], v[64:67]
    v_mfma_f32_16x16x32_bf16 v[68:71], a[248:251], v[128:131], v[68:71]
    v_mfma_f32_16x16x32_bf16 v[72:75], a[252:255], v[128:131], v[72:75]
    v_mfma_f32_16x16x32_bf16 v[76:79], v[16:19], v[128:131], v[76:79]
    s_add_u32 s33, s67, 12288
    buffer_load_dwordx4 v[128:131], v6, s[4:7], s33 offen offset:0 sc1
    s_waitcnt vmcnt(13)
    v_mfma_f32_16x16x32_bf16 v[60:63], v[20:23], v[132:135], v[60:63]
    v_mfma_f32_16x16x32_bf16 v[64:67], v[24:27], v[132:135], v[64:67]
    v_mfma_f32_16x16x32_bf16 v[68:71], v[28:31], v[132:135], v[68:71]
    v_mfma_f32_16x16x32_bf16 v[72:75], v[32:35], v[132:135], v[72:75]
    v_mfma_f32_16x16x32_bf16 v[76:79], v[36:39], v[132:135], v[76:79]
    s_add_u32 s33, s68, 12288
    buffer_load_dwordx4 v[132:135], v6, s[4:7], s33 offen offset:1024 sc1
    s_add_u32 s34, s30, 3
    s_and_b32 s34, s34, 3
    s_mul_i32 s34, s34, 15360
    s_add_u32 s34, s34, 10240
    v_add_u32 v7, s34, v13
    s_add_u32 s66, s30, 0
    s_and_b32 s66, s66, 3
    s_add_u32 s67, s66, s49
    s_mul_i32 s67, s67, 56320
    s_add_u32 s68, s67, s42
    s_waitcnt vmcnt(13)
    v_mfma_f32_16x16x32_bf16 v[40:43], a[0:3], v[80:83], 0
    v_mfma_f32_16x16x32_bf16 v[44:47], a[4:7], v[80:83], 0
    v_mfma_f32_16x16x32_bf16 v[48:51], a[8:11], v[80:83], 0
    v_mfma_f32_16x16x32_bf16 v[52:55], a[12:15], v[80:83], 0
    v_mfma_f32_16x16x32_bf16 v[56:59], a[16:19], v[80:83], 0
    s_add_u32 s33, s67, 0
    buffer_load_dwordx4 v[80:83], v6, s[4:7], s33 offen offset:0 sc1
    s_waitcnt vmcnt(13)
    v_mfma_f32_16x16x32_bf16 v[40:43], a[20:23], v[84:87], v[40:43]
    v_mfma_f32_16x16x32_bf16 v[44:47], a[24:27], v[84:87], v[44:47]
    v_mfma_f32_16x16x32_bf16 v[48:51], a[28:31], v[84:87], v[48:51]
    v_mfma_f32_16x16x32_bf16 v[52:55], a[32:35], v[84:87], v[52:55]
    v_mfma_f32_16x16x32_bf16 v[56:59], a[36:39], v[84:87], v[56:59]
    s_add_u32 s33, s67, 0
    buffer_load_dwordx4 v[84:87], v6, s[4:7], s33 offen offset:1024 sc1
    s_waitcnt vmcnt(13)
    v_mfma_f32_16x16x32_bf16 v[40:43], a[40:43], v[88:91], v[40:43]
    ds_write_b128 v8, v[60:63] offset:0
    v_mfma_f32_16x16x32_bf16 v[44:47], a[44:47], v[88:91], v[44:47]
    ds_write_b128 v8, v[64:67] offset:1024
    v_mfma_f32_16x16x32_bf16 v[48:51], a[48:51], v[88:91], v[48:51]
    ds_write_b128 v8, v[68:71] offset:2048
    v_mfma_f32_16x16x32_bf16 v[52:55], a[52:55], v[88:91], v[52:55]
    ds_write_b128 v8, v[72:75] offset:3072
    v_mfma_f32_16x16x32_bf16 v[56:59], a[56:59], v[88:91], v[56:59]
    ds_write_b128 v8, v[76:79] offset:4096
    s_add_u32 s33, s67, 0
    buffer_load_dwordx4 v[88:91], v6, s[4:7], s33 offen offset:2048 sc1
    s_waitcnt vmcnt(13)
    v_mfma_f32_16x16x32_bf16 v[40:43], a[60:63], v[92:95], v[40:43]
    v_mfma_f32_16x16x32_bf16 v[44:47], a[64:67], v[92:95], v[44:47]
    v_mfma_f32_16x16x32_bf16 v[48:51], a[68:71], v[92:95], v[48:51]
    v_mfma_f32_16x16x32_bf16 v[52:55], a[72:75], v[92:95], v[52:55]
    v_mfma_f32_16x16x32_bf16 v[56:59], a[76:79], v[92:95], v[56:59]
    s_add_u32 s33, s67, 0
    buffer_load_dwordx4 v[92:95], v6, s[4:7], s33 offen offset:3072 sc1
    s_waitcnt vmcnt(13)
    v_mfma_f32_16x16x32_bf16 v[40:43], a[80:83], v[96:99], v[40:43]
    v_mfma_f32_16x16x32_bf16 v[44:47], a[84:87], v[96:99], v[44:47]
    v_mfma_f32_16x16x32_bf16 v[48:51], a[88:91], v[96:99], v[48:51]
    v_mfma_f32_16x16x32_bf16 v[52:55], a[92:95], v[96:99], v[52:55]
    v_mfma_f32_16x16x32_bf16 v[56:59], a[96:99], v[96:99], v[56:59]
    s_add_u32 s33, s67, 4096
    buffer_load_dwordx4 v[96:99], v6, s[4:7], s33 offen offset:0 sc1
    s_waitcnt vmcnt(13)
    v_mfma_f32_16x16x32_bf16 v[40:43], a[100:103], v[100:103], v[40:43]
    v_mfma_f32_16x16x32_bf16 v[44:47], a[104:107], v[100:103], v[44:47]
    v_mfma_f32_16x16x32_bf16 v[48:51], a[108:111], v[100:103], v[48:51]
    v_mfma_f32_16x16x32_bf16 v[52:55], a[112:115], v[100:103], v[52:55]
    v_mfma_f32_16x16x32_bf16 v[56:59], a[116:119], v[100:103], v[56:59]
    s_add_u32 s33, s67, 4096
    buffer_load_dwordx4 v[100:103], v6, s[4:7], s33 offen offset:1024 sc1
    s_waitcnt vmcnt(13)
    v_mfma_f32_16x16x32_bf16 v[40:43], a[120:123], v[104:107], v[40:43]
    v_mfma_f32_16x16x32_bf16 v[44:47], a[124:127], v[104:107], v[44:47]
    v_mfma_f32_16x16x32_bf16 v[48:51], a[128:131], v[104:107], v[48:51]
    v_mfma_f32_16x16x32_bf16 v[52:55], a[132:135], v[104:107], v[52:55]
    v_mfma_f32_16x16x32_bf16 v[56:59], a[136:139], v[104:107], v[56:59]
    s_add_u32 s33, s67, 4096
    buffer_load_dwordx4 v[104:107], v6, s[4:7], s33 offen offset:2048 sc1
    s_waitcnt vmcnt(13)
    v_mfma_f32_16x16x32_bf16 v[40:43], a[140:143], v[108:111], v[40:43]
    v_mfma_f32_16x16x32_bf16 v[44:47], a[144:147], v[108:111], v[44:47]
    v_mfma_f32_16x16x32_bf16 v[48:51], a[148:151], v[108:111], v[48:51]
    v_mfma_f32_16x16x32_bf16 v[52:55], a[152:155], v[108:111], v[52:55]
    v_mfma_f32_16x16x32_bf16 v[56:59], a[156:159], v[108:111], v[56:59]
    s_add_u32 s33, s67, 4096
    buffer_load_dwordx4 v[108:111], v6, s[4:7], s33 offen offset:3072 sc1
    s_waitcnt vmcnt(13)
    v_mfma_f32_16x16x32_bf16 v[40:43], a[160:163], v[112:115], v[40:43]
    v_mfma_f32_16x16x32_bf16 v[44:47], a[164:167], v[112:115], v[44:47]
    v_mfma_f32_16x16x32_bf16 v[48:51], a[168:171], v[112:115], v[48:51]
    v_mfma_f32_16x16x32_bf16 v[52:55], a[172:175], v[112:115], v[52:55]
    v_mfma_f32_16x16x32_bf16 v[56:59], a[176:179], v[112:115], v[56:59]
    s_add_u32 s33, s67, 8192
    buffer_load_dwordx4 v[112:115], v6, s[4:7], s33 offen offset:0 sc1
    s_waitcnt vmcnt(13)
    v_mfma_f32_16x16x32_bf16 v[40:43], a[180:183], v[116:119], v[40:43]
    v_mfma_f32_16x16x32_bf16 v[44:47], a[184:187], v[116:119], v[44:47]
    v_mfma_f32_16x16x32_bf16 v[48:51], a[188:191], v[116:119], v[48:51]
    v_mfma_f32_16x16x32_bf16 v[52:55], a[192:195], v[116:119], v[52:55]
    v_mfma_f32_16x16x32_bf16 v[56:59], a[196:199], v[116:119], v[56:59]
    s_add_u32 s33, s67, 8192
    buffer_load_dwordx4 v[116:119], v6, s[4:7], s33 offen offset:1024 sc1
    s_waitcnt vmcnt(13)
    v_mfma_f32_16x16x32_bf16 v[40:43], a[200:203], v[120:123], v[40:43]
    v_mfma_f32_16x16x32_bf16 v[44:47], a[204:207], v[120:123], v[44:47]
    v_mfma_f32_16x16x32_bf16 v[48:51], a[208:211], v[120:123], v[48:51]
    v_mfma_f32_16x16x32_bf16 v[52:55], a[212:215], v[120:123], v[52:55]
    v_mfma_f32_16x16x32_bf16 v[56:59], a[216:219], v[120:123], v[56:59]
    s_add_u32 s33, s67, 8192
    buffer_load_dwordx4 v[120:123], v6, s[4:7], s33 offen offset:2048 sc1
    s_waitcnt vmcnt(13)
    v_mfma_f32_16x16x32_bf16 v[40:43], a[220:223], v[124:127], v[40:43]
    v_mfma_f32_16x16x32_bf16 v[44:47], a[224:227], v[124:127], v[44:47]
    v_mfma_f32_16x16x32_bf16 v[48:51], a[228:231], v[124:127], v[48:51]
    v_mfma_f32_16x16x32_bf16 v[52:55], a[232:235], v[124:127], v[52:55]
    v_mfma_f32_16x16x32_bf16 v[56:59], a[236:239], v[124:127], v[56:59]
    s_add_u32 s33, s67, 8192
    buffer_load_dwordx4 v[124:127], v6, s[4:7], s33 offen offset:3072 sc1
    s_waitcnt vmcnt(13)
    v_mfma_f32_16x16x32_bf16 v[40:43], a[240:243], v[128:131], v[40:43]
    v_mfma_f32_16x16x32_bf16 v[44:47], a[244:247], v[128:131], v[44:47]
    v_mfma_f32_16x16x32_bf16 v[48:51], a[248:251], v[128:131], v[48:51]
    v_mfma_f32_16x16x32_bf16 v[52:55], a[252:255], v[128:131], v[52:55]
    v_mfma_f32_16x16x32_bf16 v[56:59], v[16:19], v[128:131], v[56:59]
    s_add_u32 s33, s67, 12288
    buffer_load_dwordx4 v[128:131], v6, s[4:7], s33 offen offset:0 sc1
    s_waitcnt vmcnt(13)
    v_mfma_f32_16x16x32_bf16 v[40:43], v[20:23], v[132:135], v[40:43]
    v_mfma_f32_16x16x32_bf16 v[44:47], v[24:27], v[132:135], v[44:47]
    v_mfma_f32_16x16x32_bf16 v[48:51], v[28:31], v[132:135], v[48:51]
    v_mfma_f32_16x16x32_bf16 v[52:55], v[32:35], v[132:135], v[52:55]
    v_mfma_f32_16x16x32_bf16 v[56:59], v[36:39], v[132:135], v[56:59]
    s_add_u32 s33, s68, 12288
    buffer_load_dwordx4 v[132:135], v6, s[4:7], s33 offen offset:1024 sc1
    s_mov_b32 s12, s60
    s_and_b32 s13, s61, 0xffff
    s_mov_b32 s14, 0x280000
    s_mov_b32 s15, 0x20000
    s_mov_b32 s34, 0x900000
    buffer_load_dwordx2 v[196:197], v2, s[4:7], s34 offen offset:0 sc1
    buffer_load_dwordx2 v[198:199], v2, s[4:7], s34 offen offset:128 sc1
    buffer_load_dwordx2 v[200:201], v2, s[4:7], s34 offen offset:1024 sc1
    buffer_load_dwordx2 v[202:203], v2, s[4:7], s34 offen offset:1152 sc1
    buffer_load_dwordx2 v[204:205], v3, s[4:7], s34 offen offset:2048 sc1
    buffer_load_dwordx4 v[206:209], v11, s[4:7], 0 offen offset:0 sc1
    buffer_load_dwordx4 v[210:213], v11, s[4:7], 0 offen offset:16 sc1
    buffer_load_dwordx4 v[214:217], v11, s[4:7], 0 offen offset:128 sc1
    buffer_load_dwordx4 v[218:221], v11, s[4:7], 0 offen offset:144 sc1
    buffer_load_dwordx4 v[222:225], v12, s[4:7], 0 offen offset:256 sc1
    s_waitcnt vmcnt(23)
    v_mfma_f32_16x16x32_bf16 v[60:63], a[0:3], v[80:83], 0
    v_mfma_f32_16x16x32_bf16 v[64:67], a[4:7], v[80:83], 0
    v_mfma_f32_16x16x32_bf16 v[68:71], a[8:11], v[80:83], 0
    v_mfma_f32_16x16x32_bf16 v[72:75], a[12:15], v[80:83], 0
    v_mfma_f32_16x16x32_bf16 v[76:79], a[16:19], v[80:83], 0
    s_waitcnt vmcnt(22)
    v_mfma_f32_16x16x32_bf16 v[60:63], a[20:23], v[84:87], v[60:63]
    ds_write_b128 v7, v[40:43] offset:0
    v_mfma_f32_16x16x32_bf16 v[64:67], a[24:27], v[84:87], v[64:67]
    ds_write_b128 v7, v[44:47] offset:1024
    v_mfma_f32_16x16x32_bf16 v[68:71], a[28:31], v[84:87], v[68:71]
    ds_write_b128 v7, v[48:51] offset:2048
    v_mfma_f32_16x16x32_bf16 v[72:75], a[32:35], v[84:87], v[72:75]
    ds_write_b128 v7, v[52:55] offset:3072
    v_mfma_f32_16x16x32_bf16 v[76:79], a[36:39], v[84:87], v[76:79]
    ds_write_b128 v7, v[56:59] offset:4096
    s_waitcnt vmcnt(21)
    v_mfma_f32_16x16x32_bf16 v[60:63], a[40:43], v[88:91], v[60:63]
    v_mfma_f32_16x16x32_bf16 v[64:67], a[44:47], v[88:91], v[64:67]
    v_mfma_f32_16x16x32_bf16 v[68:71], a[48:51], v[88:91], v[68:71]
    v_mfma_f32_16x16x32_bf16 v[72:75], a[52:55], v[88:91], v[72:75]
    v_mfma_f32_16x16x32_bf16 v[76:79], a[56:59], v[88:91], v[76:79]
    s_waitcnt lgkmcnt(0)
    s_barrier
    s_waitcnt vmcnt(20)
    v_mfma_f32_16x16x32_bf16 v[60:63], a[60:63], v[92:95], v[60:63]
    ds_read_b128 v[136:139], v15 offset:0
    v_mfma_f32_16x16x32_bf16 v[64:67], a[64:67], v[92:95], v[64:67]
    ds_read_b128 v[140:143], v15 offset:1024
    v_mfma_f32_16x16x32_bf16 v[68:71], a[68:71], v[92:95], v[68:71]
    ds_read_b128 v[144:147], v15 offset:2048
    v_mfma_f32_16x16x32_bf16 v[72:75], a[72:75], v[92:95], v[72:75]
    ds_read_b128 v[148:151], v15 offset:3072
    v_mfma_f32_16x16x32_bf16 v[76:79], a[76:79], v[92:95], v[76:79]
    ds_read_b128 v[152:155], v15 offset:4096
    s_waitcnt vmcnt(19)
    v_mfma_f32_16x16x32_bf16 v[60:63], a[80:83], v[96:99], v[60:63]
    ds_read_b128 v[156:159], v15 offset:5120
    v_mfma_f32_16x16x32_bf16 v[64:67], a[84:87], v[96:99], v[64:67]
    ds_read_b128 v[160:163], v15 offset:6144
    v_mfma_f32_16x16x32_bf16 v[68:71], a[88:91], v[96:99], v[68:71]
    ds_read_b128 v[164:167], v15 offset:7168
    v_mfma_f32_16x16x32_bf16 v[72:75], a[92:95], v[96:99], v[72:75]
    ds_read_b128 v[168:171], v15 offset:8192
    v_mfma_f32_16x16x32_bf16 v[76:79], a[96:99], v[96:99], v[76:79]
    ds_read_b128 v[172:175], v15 offset:9216
    s_waitcnt vmcnt(18)
    v_mfma_f32_16x16x32_bf16 v[60:63], a[100:103], v[100:103], v[60:63]
    ds_read_b128 v[176:179], v15 offset:10240
    v_mfma_f32_16x16x32_bf16 v[64:67], a[104:107], v[100:103], v[64:67]
    ds_read_b128 v[180:183], v15 offset:11264
    v_mfma_f32_16x16x32_bf16 v[68:71], a[108:111], v[100:103], v[68:71]
    ds_read_b128 v[184:187], v15 offset:12288
    v_mfma_f32_16x16x32_bf16 v[72:75], a[112:115], v[100:103], v[72:75]
    ds_read_b128 v[188:191], v15 offset:13312
    v_mfma_f32_16x16x32_bf16 v[76:79], a[116:119], v[100:103], v[76:79]
    ds_read_b128 v[192:195], v15 offset:14336
    s_waitcnt vmcnt(17)
    v_mfma_f32_16x16x32_bf16 v[60:63], a[120:123], v[104:107], v[60:63]
    s_waitcnt lgkmcnt(5)
    v_add_f32 v136, v136, v156
    v_add_f32 v137, v137, v157
    v_mfma_f32_16x16x32_bf16 v[64:67], a[124:127], v[104:107], v[64:67]
    v_add_f32 v138, v138, v158
    v_add_f32 v139, v139, v159
    v_mfma_f32_16x16x32_bf16 v[68:71], a[128:131], v[104:107], v[68:71]
    v_add_f32 v140, v140, v160
    v_add_f32 v141, v141, v161
    v_mfma_f32_16x16x32_bf16 v[72:75], a[132:135], v[104:107], v[72:75]
    v_add_f32 v142, v142, v162
    v_add_f32 v143, v143, v163
    v_mfma_f32_16x16x32_bf16 v[76:79], a[136:139], v[104:107], v[76:79]
    v_add_f32 v144, v144, v164
    v_add_f32 v145, v145, v165
    s_waitcnt vmcnt(16)
    v_mfma_f32_16x16x32_bf16 v[60:63], a[140:143], v[108:111], v[60:63]
    v_add_f32 v146, v146, v166
    v_add_f32 v147, v147, v167
    v_mfma_f32_16x16x32_bf16 v[64:67], a[144:147], v[108:111], v[64:67]
    v_add_f32 v148, v148, v168
    v_add_f32 v149, v149, v169
    v_mfma_f32_16x16x32_bf16 v[68:71], a[148:151], v[108:111], v[68:71]
    v_add_f32 v150, v150, v170
    v_add_f32 v151, v151, v171
    v_mfma_f32_16x16x32_bf16 v[72:75], a[152:155], v[108:111], v[72:75]
    v_add_f32 v152, v152, v172
    v_add_f32 v153, v153, v173
    v_mfma_f32_16x16x32_bf16 v[76:79], a[156:159], v[108:111], v[76:79]
    v_add_f32 v154, v154, v174
    v_add_f32 v155, v155, v175
    s_waitcnt vmcnt(15)
    v_mfma_f32_16x16x32_bf16 v[60:63], a[160:163], v[112:115], v[60:63]
    s_waitcnt lgkmcnt(0)
    v_add_f32 v136, v136, v176
    v_add_f32 v137, v137, v177
    v_mfma_f32_16x16x32_bf16 v[64:67], a[164:167], v[112:115], v[64:67]
    v_add_f32 v138, v138, v178
    v_add_f32 v139, v139, v179
    v_mfma_f32_16x16x32_bf16 v[68:71], a[168:171], v[112:115], v[68:71]
    v_add_f32 v140, v140, v180
    v_add_f32 v141, v141, v181
    v_mfma_f32_16x16x32_bf16 v[72:75], a[172:175], v[112:115], v[72:75]
    v_add_f32 v142, v142, v182
    v_add_f32 v143, v143, v183
    v_mfma_f32_16x16x32_bf16 v[76:79], a[176:179], v[112:115], v[76:79]
    v_add_f32 v144, v144, v184
    v_add_f32 v145, v145, v185
    s_waitcnt vmcnt(14)
    v_mfma_f32_16x16x32_bf16 v[60:63], a[180:183], v[116:119], v[60:63]
    v_add_f32 v146, v146, v186
    v_add_f32 v147, v147, v187
    v_mfma_f32_16x16x32_bf16 v[64:67], a[184:187], v[116:119], v[64:67]
    v_add_f32 v148, v148, v188
    v_add_f32 v149, v149, v189
    v_mfma_f32_16x16x32_bf16 v[68:71], a[188:191], v[116:119], v[68:71]
    v_add_f32 v150, v150, v190
    v_add_f32 v151, v151, v191
    v_mfma_f32_16x16x32_bf16 v[72:75], a[192:195], v[116:119], v[72:75]
    v_add_f32 v152, v152, v192
    v_add_f32 v153, v153, v193
    v_mfma_f32_16x16x32_bf16 v[76:79], a[196:199], v[116:119], v[76:79]
    v_add_f32 v154, v154, v194
    v_add_f32 v155, v155, v195
    s_waitcnt vmcnt(13)
    v_mfma_f32_16x16x32_bf16 v[60:63], a[200:203], v[120:123], v[60:63]
    s_waitcnt vmcnt(0)
    v_lshlrev_b32 v226, 16, v196
    v_and_b32 v227, s35, v196
    v_mfma_f32_16x16x32_bf16 v[64:67], a[204:207], v[120:123], v[64:67]
    v_lshlrev_b32 v228, 16, v197
    v_and_b32 v229, s35, v197
    v_mfma_f32_16x16x32_bf16 v[68:71], a[208:211], v[120:123], v[68:71]
    v_lshlrev_b32 v230, 16, v198
    v_and_b32 v231, s35, v198
    v_mfma_f32_16x16x32_bf16 v[72:75], a[212:215], v[120:123], v[72:75]
    v_lshlrev_b32 v232, 16, v199
    v_and_b32 v233, s35, v199
    v_mfma_f32_16x16x32_bf16 v[76:79], a[216:219], v[120:123], v[76:79]
    v_lshlrev_b32 v234, 16, v200
    v_and_b32 v235, s35, v200
    v_mfma_f32_16x16x32_bf16 v[60:63], a[220:223], v[124:127], v[60:63]
    v_lshlrev_b32 v236, 16, v201
    v_and_b32 v237, s35, v201
    v_mfma_f32_16x16x32_bf16 v[64:67], a[224:227], v[124:127], v[64:67]
    v_lshlrev_b32 v238, 16, v202
    v_and_b32 v239, s35, v202
    v_mfma_f32_16x16x32_bf16 v[68:71], a[228:231], v[124:127], v[68:71]
    v_lshlrev_b32 v240, 16, v203
    v_and_b32 v241, s35, v203
    v_mfma_f32_16x16x32_bf16 v[72:75], a[232:235], v[124:127], v[72:75]
    v_lshlrev_b32 v242, 16, v204
    v_and_b32 v243, s35, v204
    v_mfma_f32_16x16x32_bf16 v[76:79], a[236:239], v[124:127], v[76:79]
    v_lshlrev_b32 v244, 16, v205
    v_and_b32 v245, s35, v205
    v_mfma_f32_16x16x32_bf16 v[60:63], a[240:243], v[128:131], v[60:63]
    v_fmac_f32 v226, v136, v206
    v_fmac_f32 v227, v137, v207
    v_mfma_f32_16x16x32_bf16 v[64:67], a[244:247], v[128:131], v[64:67]
    v_fmac_f32 v228, v138, v208
    v_fmac_f32 v229, v139, v209
    v_mfma_f32_16x16x32_bf16 v[68:71], a[248:251], v[128:131], v[68:71]
    v_fmac_f32 v230, v140, v210
    v_fmac_f32 v231, v141, v211
    v_mfma_f32_16x16x32_bf16 v[72:75], a[252:255], v[128:131], v[72:75]
    v_fmac_f32 v232, v142, v212
    v_fmac_f32 v233, v143, v213
    v_mfma_f32_16x16x32_bf16 v[76:79], v[16:19], v[128:131], v[76:79]
    v_fmac_f32 v234, v144, v214
    v_fmac_f32 v235, v145, v215
    v_mfma_f32_16x16x32_bf16 v[60:63], v[20:23], v[132:135], v[60:63]
    v_fmac_f32 v236, v146, v216
    v_fmac_f32 v237, v147, v217
    v_mfma_f32_16x16x32_bf16 v[64:67], v[24:27], v[132:135], v[64:67]
    v_fmac_f32 v238, v148, v218
    v_fmac_f32 v239, v149, v219
    v_mfma_f32_16x16x32_bf16 v[68:71], v[28:31], v[132:135], v[68:71]
    v_fmac_f32 v240, v150, v220
    v_fmac_f32 v241, v151, v221
    v_mfma_f32_16x16x32_bf16 v[72:75], v[32:35], v[132:135], v[72:75]
    v_fmac_f32 v242, v152, v222
    v_fmac_f32 v243, v153, v223
    v_mfma_f32_16x16x32_bf16 v[76:79], v[36:39], v[132:135], v[76:79]
    v_fmac_f32 v244, v154, v224
    v_fmac_f32 v245, v155, v225
    v_pk_fma_f32 v[60:61], v[60:61], v[206:207], v[226:227]
    v_pk_fma_f32 v[62:63], v[62:63], v[208:209], v[228:229]
    v_pk_fma_f32 v[64:65], v[64:65], v[210:211], v[230:231]
    v_pk_fma_f32 v[66:67], v[66:67], v[212:213], v[232:233]
    v_pk_fma_f32 v[68:69], v[68:69], v[214:215], v[234:235]
    v_pk_fma_f32 v[70:71], v[70:71], v[216:217], v[236:237]
    v_pk_fma_f32 v[72:73], v[72:73], v[218:219], v[238:239]
    v_pk_fma_f32 v[74:75], v[74:75], v[220:221], v[240:241]
    v_pk_fma_f32 v[76:77], v[76:77], v[222:223], v[242:243]
    v_pk_fma_f32 v[78:79], v[78:79], v[224:225], v[244:245]
    v_cvt_pk_bf16_f32 v196, v60, v61
    v_cvt_pk_bf16_f32 v197, v62, v63
    v_cvt_pk_bf16_f32 v198, v64, v65
    v_cvt_pk_bf16_f32 v199, v66, v67
    v_cvt_pk_bf16_f32 v200, v68, v69
    v_cvt_pk_bf16_f32 v201, v70, v71
    v_cvt_pk_bf16_f32 v202, v72, v73
    v_cvt_pk_bf16_f32 v203, v74, v75
    v_cvt_pk_bf16_f32 v204, v76, v77
    v_cvt_pk_bf16_f32 v205, v78, v79
    ds_write_b128 v246, v[196:199]
    ds_write_b128 v246, v[200:203] offset:64
    ds_write_b64 v247, v[204:205] offset:128
    s_waitcnt lgkmcnt(0)
    ds_read_b128 v[136:139], v248
    ds_read_b128 v[140:143], v249
    ds_read_b128 v[144:147], v250
    s_waitcnt lgkmcnt(2)
    buffer_store_dwordx4 v[136:139], v251, s[12:15], 0 offen
    s_waitcnt lgkmcnt(1)
    buffer_store_dwordx4 v[140:143], v252, s[12:15], 0 offen
    s_waitcnt lgkmcnt(0)
    buffer_store_dwordx4 v[144:147], v253, s[12:15], 0 offen
L_end:
    s_endpgm
.section .rodata,"a"
.p2align 6
.amdhsa_kernel adaLN_cond__ssm_conv_h3__glu_gated_bilinear__prompt_kernel
  .amdhsa_next_free_vgpr 512
  .amdhsa_next_free_sgpr 102
  .amdhsa_accum_offset 256
  .amdhsa_group_segment_fixed_size 0
  .amdhsa_kernarg_size 120
  .amdhsa_user_sgpr_count 2
  .amdhsa_user_sgpr_kernarg_segment_ptr 1
  .amdhsa_system_sgpr_workgroup_id_x 1
  .amdhsa_float_denorm_mode_32 3
.end_amdhsa_kernel
```
